```python
import torch

def _softmax(x, axis=-1):
    return torch.softmax(x, dim=axis)
def _gelu(x):
    return torch.nn.functional.gelu(x, approximate="tanh")
def _silu(x):
    return torch.nn.functional.silu(x)
def _sigmoid(x):
    return torch.sigmoid(x)
def _layernorm(x, axis=-1, eps=1e-5):
    m = x.mean(dim=axis, keepdim=True)
    v = x.var(dim=axis, keepdim=True, unbiased=False)
    return (x - m) / torch.sqrt(v + eps)
def _scatter_add(tgt, idx, src, axis=0):
    return tgt.clone().index_add_(axis, idx, src)
def _segment_sum(src, seg, n):
    out = torch.zeros((n,) + src.shape[1:], dtype=src.dtype)
    return out.index_add_(0, seg, src)
def _pad(x, pw):
    flat = tuple(v for pair in reversed(pw) for v in pair)
    return torch.nn.functional.pad(x, flat)

kernel_name = 'sequential_preLN__compressed_kv_cla__dense_activation_gelu__decode'

def setup_inputs():

    _w = (lambda a: (lambda t: t.to(torch.bfloat16) if t.is_floating_point() else t)(torch.as_tensor(a)))
    def _A_setup():
        B, H, Sq, Sk, D, M = 1, 32, 1, 16384, 128, 512
        Dc = 4 * D
        return {
            "x": _w((lambda *s: torch.randn(*s, dtype=torch.bfloat16) * 0.05)(B, Sq, M)),
            "c_kv": _w((lambda *s: torch.randn(*s, dtype=torch.bfloat16) * 0.8)(B, Sk, Dc)),
            "w_q": _w((lambda *s: torch.randn(*s, dtype=torch.bfloat16) * 3.2)(M, H, D) * (M ** -0.5)),
            "w_uk": _w((lambda *s: torch.randn(*s, dtype=torch.bfloat16) * 3.2)(Dc, H, D) * (Dc ** -0.5)),
            "w_uv": _w((lambda *s: torch.randn(*s, dtype=torch.bfloat16) * 0.8)(Dc, H, D) * (Dc ** -0.5)),
            "w_o": _w((lambda *s: torch.randn(*s, dtype=torch.bfloat16) * 0.8)(H, D, M) * ((H * D) ** -0.5)),
        }
    _A_in = _A_setup()

    def _B_setup():
        B, S, D, F = 1, 1, 512, 1792
        return {
            "x": _w((lambda *s: torch.randn(*s, dtype=torch.bfloat16) * 0.05)(B, S, D)),
            "w1": _w((lambda *s: torch.randn(*s, dtype=torch.bfloat16) * 3.2)(D, F) * (D ** -0.5)),
            "b1": _w((lambda *s: torch.randn(*s, dtype=torch.bfloat16) * 3.2)(F) * 0.01),
            "w2": _w((lambda *s: torch.randn(*s, dtype=torch.bfloat16) * 0.8)(F, D) * (F ** -0.5)),
            "b2": _w((lambda *s: torch.randn(*s, dtype=torch.bfloat16) * 0.8)(D) * 0.01),
        }
    _B_in = _B_setup()

    return {
        "A_x": _A_in["x"],
        "A_c_kv": _A_in["c_kv"],
        "A_w_q": _A_in["w_q"],
        "A_w_uk": _A_in["w_uk"],
        "A_w_uv": _A_in["w_uv"],
        "A_w_o": _A_in["w_o"],
        "B_x": _B_in["x"],
        "B_w1": _B_in["w1"],
        "B_b1": _B_in["b1"],
        "B_w2": _B_in["w2"],
        "B_b2": _B_in["b2"],
    }

def reference(A_x, A_c_kv, A_w_q, A_w_uk, A_w_uv, A_w_o, B_x, B_w1, B_b1, B_w2, B_b2):
    def _A_ref(x, c_kv, w_q, w_uk, w_uv, w_o):
        B, Sq, M = x.shape[0], x.shape[1], x.shape[2]
        Sk = c_kv.shape[1]
        H, D = w_q.shape[1], w_q.shape[2]
        q = torch.einsum("bqm,mhd->bhqd", x, w_q)
        k = torch.einsum("bkc,chd->bhkd", c_kv, w_uk)
        v = torch.einsum("bkc,chd->bhkd", c_kv, w_uv)
        scores = torch.einsum("bhqd,bhkd->bhqk", q, k) * (D ** -0.5)
        off = Sk - Sq
        qi = torch.arange(Sq)[:, None]
        kj = torch.arange(Sk)[None, :]
        cmask = kj <= (qi + off)
        scores = torch.where(cmask[None, None], scores, -1e9)
        p = _softmax(scores, axis=-1)
        ctx = torch.einsum("bhqk,bhkd->bhqd", p, v)
        return torch.einsum("bhqd,hdm->bqm", ctx, w_o)

    def _B_ref(x, w1, b1, w2, b2):
        h = torch.einsum("bsd,df->bsf", x, w1) + b1
        h = _gelu(h)
        return torch.einsum("bsf,fd->bsd", h, w2) + b2

    x = A_x
    h = x + _A_ref(_layernorm(x, axis=-1), A_c_kv, A_w_q, A_w_uk, A_w_uv, A_w_o)
    h2 = h + _B_ref(_layernorm(h, axis=-1), B_w1, B_b1, B_w2, B_b2)
    return h2
```

```asm
; @launch grid=(256,1,1) block=(512,1,1) lds=153600
.amdgcn_target "amdgcn-amd-amdhsa--gfx950"
.text
.globl sequential_preLN__compressed_kv_cla__dense_activation_gelu__decode_kernel
.p2align 8
.type sequential_preLN__compressed_kv_cla__dense_activation_gelu__decode_kernel,@function
sequential_preLN__compressed_kv_cla__dense_activation_gelu__decode_kernel:
    s_load_dwordx2 s[4:5], s[0:1], 0
    s_load_dwordx2 s[12:13], s[0:1], 16
    s_load_dwordx2 s[48:49], s[0:1], 104
    v_readfirstlane_b32 s3, v0
    s_cmp_ge_u32 s2, 256
    s_cbranch_scc1 L_end
    v_and_b32 v1, 63, v0
    v_and_b32 v2, 15, v0
    v_bfe_u32 v3, v0, 4, 2
    s_lshr_b32 s3, s3, 6
    s_and_b32 s58, s2, 7
    s_lshr_b32 s59, s2, 3
    s_lshr_b32 s70, s59, 4
    s_lshl_b32 s60, s58, 1
    s_add_u32 s60, s60, s70
    s_and_b32 s70, s59, 1
    s_lshl_b32 s70, s70, 4
    s_add_u32 s60, s60, s70
    s_bfe_u32 s61, s59, 0x30001
    s_and_b32 s64, s3, 3
    s_cmp_lt_u32 s3, 4
    s_cbranch_scc1 L_arole
    s_setprio 3
    s_cmp_eq_u32 s64, 1
    s_cbranch_scc1 L_s1b
    s_cmp_ge_u32 s64, 2
    s_cbranch_scc1 L_sidle

    s_mov_b32 s6, 0x400
    s_mov_b32 s7, 0x20000
    s_mov_b32 s14, 0x400000
    s_mov_b32 s15, 0x20000
    v_lshlrev_b32 v4, 4, v1
    v_lshlrev_b32 v5, 5, v3
    v_lshlrev_b32 v6, 17, v3
    v_lshl_add_u32 v6, v2, 4, v6
    s_lshl_b32 s70, s61, 7
    s_lshl_b32 s71, s61, 19
    s_lshl_b32 s72, s60, 8
    s_add_u32 s71, s71, s72
    s_waitcnt lgkmcnt(0)
    s_load_dword s57, s[48:49], 0
    buffer_load_dwordx4 v[8:11], v5, s[4:7], s70 offen
    buffer_load_dwordx4 v[12:15], v5, s[4:7], s70 offen offset:16
    buffer_load_dwordx4 v[16:19], v4, s[4:7], 0 offen

    buffer_load_dwordx4 v[64:67], v6, s[12:15], s71 offen nt
    s_addk_i32 s71, 0x2000
    buffer_load_dwordx4 v[68:71], v6, s[12:15], s71 offen nt
    s_addk_i32 s71, 0x2000
    buffer_load_dwordx4 v[72:75], v6, s[12:15], s71 offen nt
    s_addk_i32 s71, 0x2000
    buffer_load_dwordx4 v[76:79], v6, s[12:15], s71 offen nt
    s_addk_i32 s71, 0x2000
    buffer_load_dwordx4 v[80:83], v6, s[12:15], s71 offen nt
    s_addk_i32 s71, 0x2000
    buffer_load_dwordx4 v[84:87], v6, s[12:15], s71 offen nt
    s_addk_i32 s71, 0x2000
    buffer_load_dwordx4 v[88:91], v6, s[12:15], s71 offen nt
    s_addk_i32 s71, 0x2000
    buffer_load_dwordx4 v[92:95], v6, s[12:15], s71 offen nt
    s_addk_i32 s71, 0x2000
    buffer_load_dwordx4 v[96:99], v6, s[12:15], s71 offen nt
    s_addk_i32 s71, 0x2000
    buffer_load_dwordx4 v[100:103], v6, s[12:15], s71 offen nt
    s_addk_i32 s71, 0x2000
    buffer_load_dwordx4 v[104:107], v6, s[12:15], s71 offen nt
    s_addk_i32 s71, 0x2000
    buffer_load_dwordx4 v[108:111], v6, s[12:15], s71 offen nt
    s_addk_i32 s71, 0x2000
    buffer_load_dwordx4 v[112:115], v6, s[12:15], s71 offen nt
    s_addk_i32 s71, 0x2000
    buffer_load_dwordx4 v[116:119], v6, s[12:15], s71 offen nt
    s_addk_i32 s71, 0x2000
    buffer_load_dwordx4 v[120:123], v6, s[12:15], s71 offen nt
    s_addk_i32 s71, 0x2000
    buffer_load_dwordx4 v[124:127], v6, s[12:15], s71 offen nt
    s_barrier
    s_load_dwordx2 s[20:21], s[0:1], 32
    s_load_dwordx2 s[24:25], s[0:1], 40
    s_load_dwordx2 s[28:29], s[0:1], 56
    s_load_dwordx2 s[32:33], s[0:1], 64
    s_load_dwordx2 s[36:37], s[0:1], 72
    s_load_dwordx2 s[40:41], s[0:1], 80
    s_load_dwordx2 s[44:45], s[0:1], 88
    s_mov_b32 s22, 0x400000
    s_mov_b32 s23, 0x20000
    s_mov_b32 s26, 0x400000
    s_mov_b32 s27, 0x20000
    s_mov_b32 s30, 0x1c0000
    s_mov_b32 s31, 0x20000
    s_mov_b32 s34, 0xe00
    s_mov_b32 s35, 0x20000
    s_mov_b32 s38, 0x1c0000
    s_mov_b32 s39, 0x20000
    s_mov_b32 s42, 0x400
    s_mov_b32 s43, 0x20000
    s_mov_b32 s46, 0x400
    s_mov_b32 s47, 0x20000
    s_mov_b32 s6, 0x400
    s_mov_b32 s7, 0x20000
    s_mov_b32 s50, 0x10000000
    s_mov_b32 s51, 0x20000
    s_lshr_b32 s70, s59, 1
    s_lshl_b32 s62, s58, 4
    s_add_u32 s62, s62, s70
    s_and_b32 s63, s59, 1
    s_cmp_eq_u32 s63, 1
    s_cselect_b32 s54, s70, 31
    s_mul_i32 s65, s58, 7
    s_add_u32 s65, s65, s54
    s_sub_u32 s55, s54, 7
    s_mov_b32 s76, 0x07060302

    s_lshl_b32 s67, s64, 2
    s_add_u32 s67, s67, 147968
    v_mov_b32 v255, s67
    v_mov_b32 v254, 1
    v_mov_b32 v253, 147968
    v_mov_b32 v36, 0x100
    v_mov_b32 v37, 0x504
    v_cmp_gt_u32 vcc, 8, v2
    s_nop 1
    v_cndmask_b32 v36, v37, v36, vcc
    v_or_b32 v37, 0x0c0c0000, v36
    v_lshlrev_b32 v36, 16, v36
    v_or_b32 v36, 0x0c0c, v36
    v_and_b32 v38, 1, v2
    v_cmp_eq_u32 vcc, 0, v38
    s_nop 1
    v_cndmask_b32 v36, v36, v37, vcc
    v_bfe_u32 v38, v2, 1, 2
    v_mov_b32 v37, 0x0c0c0c0c

    v_cmp_eq_u32 vcc, 0, v38
    s_nop 1
    v_cndmask_b32 v20, v37, v36, vcc
    v_cmp_eq_u32 vcc, 1, v38
    s_nop 1
    v_cndmask_b32 v21, v37, v36, vcc
    v_cmp_eq_u32 vcc, 2, v38
    s_nop 1
    v_cndmask_b32 v22, v37, v36, vcc
    v_cmp_eq_u32 vcc, 3, v38
    s_nop 1
    v_cndmask_b32 v23, v37, v36, vcc
    v_mov_b32 v36, 0x302
    v_mov_b32 v37, 0x504
    v_cmp_gt_u32 vcc, 8, v2
    s_nop 1
    v_cndmask_b32 v36, v37, v36, vcc
    v_or_b32 v37, 0x0c0c0000, v36
    v_lshlrev_b32 v36, 16, v36
    v_or_b32 v36, 0x0c0c, v36
    v_and_b32 v38, 1, v2
    v_cmp_eq_u32 vcc, 0, v38
    s_nop 1
    v_cndmask_b32 v36, v36, v37, vcc
    v_bfe_u32 v38, v2, 1, 2
    v_mov_b32 v37, 0x0c0c0c0c

    v_cmp_eq_u32 vcc, 0, v38
    s_nop 1
    v_cndmask_b32 v24, v37, v36, vcc
    v_cmp_eq_u32 vcc, 1, v38
    s_nop 1
    v_cndmask_b32 v25, v37, v36, vcc
    v_cmp_eq_u32 vcc, 2, v38
    s_nop 1
    v_cndmask_b32 v26, v37, v36, vcc
    v_cmp_eq_u32 vcc, 3, v38
    s_nop 1
    v_cndmask_b32 v27, v37, v36, vcc
    v_mov_b32 v28, 0x3f803f80
    s_lshl_b32 s70, s60, 12
    s_add_u32 s70, s70, 65536
    s_lshl_b32 s71, s61, 9
    s_add_u32 s71, s71, s70
    v_mov_b32 v50, 0
    s_waitcnt vmcnt(16)

    v_lshlrev_b32 v40, 16, v16
    v_and_b32 v41, 0xffff0000, v16
    v_lshlrev_b32 v42, 16, v17
    v_and_b32 v43, 0xffff0000, v17
    v_lshlrev_b32 v44, 16, v18
    v_and_b32 v45, 0xffff0000, v18
    v_lshlrev_b32 v46, 16, v19
    v_and_b32 v47, 0xffff0000, v19
    v_add_f32 v36, v40, v41
    v_mul_f32 v37, v40, v40
    v_fmac_f32 v37, v41, v41
    v_add_f32 v36, v36, v42
    v_fmac_f32 v37, v42, v42
    v_add_f32 v36, v36, v43
    v_fmac_f32 v37, v43, v43
    v_add_f32 v36, v36, v44
    v_fmac_f32 v37, v44, v44
    v_add_f32 v36, v36, v45
    v_fmac_f32 v37, v45, v45
    v_add_f32 v36, v36, v46
    v_fmac_f32 v37, v46, v46
    v_add_f32 v36, v36, v47
    v_fmac_f32 v37, v47, v47
    v_perm_b32 v128, v28, v8, v20
    v_perm_b32 v129, v28, v8, v21
    v_perm_b32 v130, v28, v8, v22
    v_perm_b32 v131, v28, v8, v23
    v_add_f32_dpp v36, v36, v36 quad_perm:[1,0,3,2] row_mask:0xf bank_mask:0xf
    v_add_f32_dpp v37, v37, v37 quad_perm:[1,0,3,2] row_mask:0xf bank_mask:0xf
    v_perm_b32 v132, v28, v8, v24
    v_perm_b32 v133, v28, v8, v25
    v_perm_b32 v134, v28, v8, v26
    v_perm_b32 v135, v28, v8, v27
    v_add_f32_dpp v36, v36, v36 quad_perm:[2,3,0,1] row_mask:0xf bank_mask:0xf
    v_add_f32_dpp v37, v37, v37 quad_perm:[2,3,0,1] row_mask:0xf bank_mask:0xf
    s_waitcnt vmcnt(15)
    v_mfma_f32_16x16x32_bf16 v[52:55], v[128:131], v[64:67], 0
    v_perm_b32 v136, v28, v9, v20
    v_perm_b32 v137, v28, v9, v21
    v_perm_b32 v138, v28, v9, v22
    v_perm_b32 v139, v28, v9, v23
    v_add_f32_dpp v36, v36, v36 row_half_mirror row_mask:0xf bank_mask:0xf
    v_add_f32_dpp v37, v37, v37 row_half_mirror row_mask:0xf bank_mask:0xf
    s_waitcnt vmcnt(14)
    v_mfma_f32_16x16x32_bf16 v[52:55], v[132:135], v[68:71], v[52:55]
    v_perm_b32 v140, v28, v9, v24
    v_perm_b32 v141, v28, v9, v25
    v_perm_b32 v142, v28, v9, v26
    v_perm_b32 v143, v28, v9, v27
    v_add_f32_dpp v36, v36, v36 row_mirror row_mask:0xf bank_mask:0xf
    v_add_f32_dpp v37, v37, v37 row_mirror row_mask:0xf bank_mask:0xf
    s_waitcnt vmcnt(13)
    v_mfma_f32_16x16x32_bf16 v[52:55], v[136:139], v[72:75], v[52:55]
    v_perm_b32 v144, v28, v10, v20
    v_perm_b32 v145, v28, v10, v21
    v_perm_b32 v146, v28, v10, v22
    v_perm_b32 v147, v28, v10, v23
    v_mov_b32 v38, v36
    v_mov_b32 v39, v37
    s_waitcnt vmcnt(12)
    v_mfma_f32_16x16x32_bf16 v[52:55], v[140:143], v[76:79], v[52:55]
    v_perm_b32 v148, v28, v10, v24
    v_perm_b32 v149, v28, v10, v25
    v_perm_b32 v150, v28, v10, v26
    v_perm_b32 v151, v28, v10, v27
    v_permlane16_swap_b32 v36, v38
    v_permlane16_swap_b32 v37, v39
    v_add_f32 v36, v36, v38
    v_add_f32 v37, v37, v39
    s_waitcnt vmcnt(11)
    v_mfma_f32_16x16x32_bf16 v[52:55], v[144:147], v[80:83], v[52:55]
    v_perm_b32 v152, v28, v11, v20
    v_perm_b32 v153, v28, v11, v21
    v_perm_b32 v154, v28, v11, v22
    v_perm_b32 v155, v28, v11, v23
    v_mov_b32 v38, v36
    v_mov_b32 v39, v37
    s_waitcnt vmcnt(10)
    v_mfma_f32_16x16x32_bf16 v[52:55], v[148:151], v[84:87], v[52:55]
    v_perm_b32 v156, v28, v11, v24
    v_perm_b32 v157, v28, v11, v25
    v_perm_b32 v158, v28, v11, v26
    v_perm_b32 v159, v28, v11, v27
    v_permlane32_swap_b32 v36, v38
    v_permlane32_swap_b32 v37, v39
    v_add_f32 v36, v36, v38
    v_add_f32 v37, v37, v39
    s_waitcnt vmcnt(9)
    v_mfma_f32_16x16x32_bf16 v[52:55], v[152:155], v[88:91], v[52:55]
    v_perm_b32 v160, v28, v12, v20
    v_perm_b32 v161, v28, v12, v21
    v_perm_b32 v162, v28, v12, v22
    v_perm_b32 v163, v28, v12, v23
    v_mul_f32 v36, 0x3b000000, v36
    v_mul_f32 v37, 0x3b000000, v37
    v_fma_f32 v37, -v36, v36, v37
    v_max_f32 v37, 0, v37
    v_add_f32 v37, 0x3727c5ac, v37
    v_rsq_f32 v37, v37
    s_waitcnt vmcnt(8)
    v_mfma_f32_16x16x32_bf16 v[52:55], v[156:159], v[92:95], v[52:55]
    v_perm_b32 v164, v28, v12, v24
    v_perm_b32 v165, v28, v12, v25
    v_perm_b32 v166, v28, v12, v26
    v_perm_b32 v167, v28, v12, v27
    s_waitcnt vmcnt(7)
    v_mfma_f32_16x16x32_bf16 v[52:55], v[160:163], v[96:99], v[52:55]
    v_perm_b32 v168, v28, v13, v20
    v_perm_b32 v169, v28, v13, v21
    v_perm_b32 v170, v28, v13, v22
    v_perm_b32 v171, v28, v13, v23
    s_waitcnt vmcnt(6)
    v_mfma_f32_16x16x32_bf16 v[52:55], v[164:167], v[100:103], v[52:55]
    v_perm_b32 v172, v28, v13, v24
    v_perm_b32 v173, v28, v13, v25
    v_perm_b32 v174, v28, v13, v26
    v_perm_b32 v175, v28, v13, v27
    s_waitcnt vmcnt(5)
    v_mfma_f32_16x16x32_bf16 v[52:55], v[168:171], v[104:107], v[52:55]
    v_perm_b32 v176, v28, v14, v20
    v_perm_b32 v177, v28, v14, v21
    v_perm_b32 v178, v28, v14, v22
    v_perm_b32 v179, v28, v14, v23
    s_waitcnt vmcnt(4)
    v_mfma_f32_16x16x32_bf16 v[52:55], v[172:175], v[108:111], v[52:55]
    v_perm_b32 v180, v28, v14, v24
    v_perm_b32 v181, v28, v14, v25
    v_perm_b32 v182, v28, v14, v26
    v_perm_b32 v183, v28, v14, v27
    s_waitcnt vmcnt(3)
    v_mfma_f32_16x16x32_bf16 v[52:55], v[176:179], v[112:115], v[52:55]
    v_perm_b32 v184, v28, v15, v20
    v_perm_b32 v185, v28, v15, v21
    v_perm_b32 v186, v28, v15, v22
    v_perm_b32 v187, v28, v15, v23
    s_waitcnt vmcnt(2)
    v_mfma_f32_16x16x32_bf16 v[52:55], v[180:183], v[116:119], v[52:55]
    v_perm_b32 v188, v28, v15, v24
    v_perm_b32 v189, v28, v15, v25
    v_perm_b32 v190, v28, v15, v26
    v_perm_b32 v191, v28, v15, v27
    s_waitcnt vmcnt(1)
    v_mfma_f32_16x16x32_bf16 v[52:55], v[184:187], v[120:123], v[52:55]
    s_waitcnt lgkmcnt(0)
    s_add_u32 s57, s57, 1
    s_and_b32 s56, s57, 0x3fff
    s_lshl_b32 s67, s57, 2
    s_and_b32 s67, s67, 0x3fff0000
    s_or_b32 s56, s56, s67
    s_and_b32 s52, s57, 0xff
    s_mul_i32 s67, s52, 0x01000100
    s_and_b32 s68, s57, 0xff00ff00
    s_add_u32 s67, s67, s68
    s_and_b32 s67, s67, 0xff00ff00
    s_or_b32 s69, s52, s67
    s_lshl_b32 s67, s52, 16
    s_add_u32 s67, s67, s57
    s_and_b32 s67, s67, 0x00ff0000
    s_or_b32 s52, s69, s67
    s_mov_b32 s53, 0x00010001
    v_mov_b32 v51, s56
    s_waitcnt vmcnt(0)
    v_mfma_f32_16x16x32_bf16 v[52:55], v[188:191], v[124:127], v[52:55]
    s_nop 7
    v_mov_b32 v44, v52
    v_mov_b32 v45, v53
    v_mov_b32 v46, v54
    v_mov_b32 v47, v55
    v_permlane32_swap_b32 v52, v44
    v_permlane32_swap_b32 v53, v45
    v_permlane32_swap_b32 v54, v46
    v_permlane32_swap_b32 v55, v47
    v_fma_f32 v40, -v36, v44, v52
    v_fma_f32 v41, -v36, v45, v53
    v_fma_f32 v42, -v36, v46, v54
    v_fma_f32 v43, -v36, v47, v55
    v_mul_f32 v40, v37, v40
    v_mul_f32 v41, v37, v41
    v_mul_f32 v42, v37, v42
    v_mul_f32 v43, v37, v43
    v_cvt_pk_bf16_f32 v48, v40, v41
    v_cvt_pk_bf16_f32 v49, v42, v43
    s_add_u32 s68, s71, 2097152
    s_mov_b32 exec_hi, 0
    buffer_store_dwordx4 v[48:51], v4, s[48:51], s68 offen offset:0
    buffer_store_dwordx4 v[48:51], v4, s[48:51], s71 offen offset:0 sc1
    s_mov_b64 exec, -1
    ds_write_b32 v253, v254 offset:0
    s_branch L_s_qg
L_s1b:
    s_load_dwordx2 s[16:17], s[0:1], 24
    s_mov_b32 s18, 0x400000
    s_mov_b32 s19, 0x20000
    s_mov_b32 s50, 0x10000000
    s_mov_b32 s51, 0x20000
    s_lshl_b32 s71, s61, 19
    s_lshl_b32 s72, s60, 8
    s_add_u32 s71, s71, s72
    v_lshlrev_b32 v5, 13, v3
    v_lshlrev_b32 v4, 4, v1
    s_lshl_b32 s70, s60, 12
    s_add_u32 s70, s70, 2162688
    s_waitcnt lgkmcnt(0)
    s_load_dword s57, s[48:49], 0

    buffer_load_dwordx4 v[244:247], v4, s[48:51], s70 offen offset:0
    buffer_load_dwordx4 v[244:247], v4, s[48:51], s70 offen offset:1024
    buffer_load_dwordx4 v[244:247], v4, s[48:51], s70 offen offset:2048
    buffer_load_dwordx4 v[244:247], v4, s[48:51], s70 offen offset:3072
    s_barrier
    v_xor_b32 v6, 0, v2
    v_lshl_add_u32 v8, v6, 4, v5
    s_mov_b32 m0, 131072
    s_add_u32 s72, s71, 0
    buffer_load_dwordx4 v8, s[16:19], s72 offen nt lds

    v_xor_b32 v6, 2, v2
    v_lshl_add_u32 v9, v6, 4, v5
    s_mov_b32 m0, 132096
    s_add_u32 s72, s71, 32768
    buffer_load_dwordx4 v9, s[16:19], s72 offen nt lds

    v_xor_b32 v6, 4, v2
    v_lshl_add_u32 v10, v6, 4, v5
    s_mov_b32 m0, 133120
    s_add_u32 s72, s71, 65536
    buffer_load_dwordx4 v10, s[16:19], s72 offen nt lds

    v_xor_b32 v6, 6, v2
    v_lshl_add_u32 v11, v6, 4, v5
    s_mov_b32 m0, 134144
    s_add_u32 s72, s71, 98304
    buffer_load_dwordx4 v11, s[16:19], s72 offen nt lds

    v_xor_b32 v6, 8, v2
    v_lshl_add_u32 v8, v6, 4, v5
    s_mov_b32 m0, 135168
    s_add_u32 s72, s71, 131072
    buffer_load_dwordx4 v8, s[16:19], s72 offen nt lds

    v_xor_b32 v6, 10, v2
    v_lshl_add_u32 v9, v6, 4, v5
    s_mov_b32 m0, 136192
    s_add_u32 s72, s71, 163840
    buffer_load_dwordx4 v9, s[16:19], s72 offen nt lds

    v_xor_b32 v6, 12, v2
    v_lshl_add_u32 v10, v6, 4, v5
    s_mov_b32 m0, 137216
    s_add_u32 s72, s71, 196608
    buffer_load_dwordx4 v10, s[16:19], s72 offen nt lds

    v_xor_b32 v6, 14, v2
    v_lshl_add_u32 v11, v6, 4, v5
    s_mov_b32 m0, 138240
    s_add_u32 s72, s71, 229376
    buffer_load_dwordx4 v11, s[16:19], s72 offen nt lds

    v_xor_b32 v6, 1, v2
    v_lshl_add_u32 v8, v6, 4, v5
    s_mov_b32 m0, 139264
    s_add_u32 s72, s71, 262144
    buffer_load_dwordx4 v8, s[16:19], s72 offen nt lds

    v_xor_b32 v6, 3, v2
    v_lshl_add_u32 v9, v6, 4, v5
    s_mov_b32 m0, 140288
    s_add_u32 s72, s71, 294912
    buffer_load_dwordx4 v9, s[16:19], s72 offen nt lds

    v_xor_b32 v6, 5, v2
    v_lshl_add_u32 v10, v6, 4, v5
    s_mov_b32 m0, 141312
    s_add_u32 s72, s71, 327680
    buffer_load_dwordx4 v10, s[16:19], s72 offen nt lds

    v_xor_b32 v6, 7, v2
    v_lshl_add_u32 v11, v6, 4, v5
    s_mov_b32 m0, 142336
    s_add_u32 s72, s71, 360448
    buffer_load_dwordx4 v11, s[16:19], s72 offen nt lds

    v_xor_b32 v6, 9, v2
    v_lshl_add_u32 v8, v6, 4, v5
    s_mov_b32 m0, 143360
    s_add_u32 s72, s71, 393216
    buffer_load_dwordx4 v8, s[16:19], s72 offen nt lds

    v_xor_b32 v6, 11, v2
    v_lshl_add_u32 v9, v6, 4, v5
    s_mov_b32 m0, 144384
    s_add_u32 s72, s71, 425984
    buffer_load_dwordx4 v9, s[16:19], s72 offen nt lds

    v_xor_b32 v6, 13, v2
    v_lshl_add_u32 v10, v6, 4, v5
    s_mov_b32 m0, 145408
    s_add_u32 s72, s71, 458752
    buffer_load_dwordx4 v10, s[16:19], s72 offen nt lds

    v_xor_b32 v6, 15, v2
    v_lshl_add_u32 v11, v6, 4, v5
    s_mov_b32 m0, 146432
    s_add_u32 s72, s71, 491520
    buffer_load_dwordx4 v11, s[16:19], s72 offen nt lds

    s_load_dwordx2 s[20:21], s[0:1], 32
    s_load_dwordx2 s[24:25], s[0:1], 40
    s_load_dwordx2 s[28:29], s[0:1], 56
    s_load_dwordx2 s[32:33], s[0:1], 64
    s_load_dwordx2 s[36:37], s[0:1], 72
    s_load_dwordx2 s[40:41], s[0:1], 80
    s_load_dwordx2 s[44:45], s[0:1], 88
    s_mov_b32 s22, 0x400000
    s_mov_b32 s23, 0x20000
    s_mov_b32 s26, 0x400000
    s_mov_b32 s27, 0x20000
    s_mov_b32 s30, 0x1c0000
    s_mov_b32 s31, 0x20000
    s_mov_b32 s34, 0xe00
    s_mov_b32 s35, 0x20000
    s_mov_b32 s38, 0x1c0000
    s_mov_b32 s39, 0x20000
    s_mov_b32 s42, 0x400
    s_mov_b32 s43, 0x20000
    s_mov_b32 s46, 0x400
    s_mov_b32 s47, 0x20000
    s_mov_b32 s6, 0x400
    s_mov_b32 s7, 0x20000
    s_lshr_b32 s70, s59, 1
    s_lshl_b32 s62, s58, 4
    s_add_u32 s62, s62, s70
    s_and_b32 s63, s59, 1
    s_cmp_eq_u32 s63, 1
    s_cselect_b32 s54, s70, 31
    s_mul_i32 s65, s58, 7
    s_add_u32 s65, s65, s54
    s_sub_u32 s55, s54, 7
    s_mov_b32 s76, 0x07060302

    s_lshl_b32 s67, s64, 2
    s_add_u32 s67, s67, 147968
    v_mov_b32 v255, s67
    v_mov_b32 v254, 1
    v_mov_b32 v253, 147968
    v_and_b32 v37, 7, v2
    v_lshrrev_b32 v36, 3, v2
    v_lshl_or_b32 v36, v37, 1, v36
    v_add_u32 v37, 0, v3
    v_xor_b32 v37, v37, v36
    v_lshlrev_b32 v37, 4, v37
    v_lshl_add_u32 v37, v2, 10, v37
    v_add_u32 v12, 131072, v37

    v_add_u32 v37, 4, v3
    v_xor_b32 v37, v37, v36
    v_lshlrev_b32 v37, 4, v37
    v_lshl_add_u32 v37, v2, 10, v37
    v_add_u32 v13, 131072, v37

    v_add_u32 v37, 8, v3
    v_xor_b32 v37, v37, v36
    v_lshlrev_b32 v37, 4, v37
    v_lshl_add_u32 v37, v2, 10, v37
    v_add_u32 v14, 131072, v37

    v_add_u32 v37, 12, v3
    v_xor_b32 v37, v37, v36
    v_lshlrev_b32 v37, 4, v37
    v_lshl_add_u32 v37, v2, 10, v37
    v_add_u32 v15, 131072, v37

    v_lshrrev_b32 v31, 3, v2
    v_and_b32 v6, 7, v2
    v_lshl_add_u32 v7, v31, 4, v3
    v_lshlrev_b32 v7, 4, v7
    v_lshl_add_u32 v7, v6, 9, v7
    v_sub_u32 v30, 0, v31
    v_not_b32 v31, v30
    s_lshl_b32 s70, s60, 12
    s_add_u32 s70, s70, 65536
    v_lshlrev_b32 v4, 3, v2
    s_lshl_b32 s73, s60, 10
    s_lshl_b32 s71, s61, 7
    s_add_u32 s73, s73, s71
    s_add_u32 s73, s73, 196608
    v_lshlrev_b32 v6, 1, v6
    v_add_u32 v5, 1, v6
    s_waitcnt lgkmcnt(0)

    s_add_u32 s57, s57, 1
    s_and_b32 s56, s57, 0x3fff
    s_lshl_b32 s67, s57, 2
    s_and_b32 s67, s67, 0x3fff0000
    s_or_b32 s56, s56, s67
    s_and_b32 s52, s57, 0xff
    s_mul_i32 s67, s52, 0x01000100
    s_and_b32 s68, s57, 0xff00ff00
    s_add_u32 s67, s67, s68
    s_and_b32 s67, s67, 0xff00ff00
    s_or_b32 s69, s52, s67
    s_lshl_b32 s67, s52, 16
    s_add_u32 s67, s67, s57
    s_and_b32 s67, s67, 0x00ff0000
    s_or_b32 s52, s69, s67
    s_mov_b32 s53, 0x00010001
    v_lshlrev_b32 v36, 1, v6
    v_lshrrev_b32 v36, v36, s52
    v_bfe_u32 v50, v36, 1, 1
    v_and_b32 v36, 1, v36
    v_lshl_or_b32 v50, v50, 16, v36

    v_lshlrev_b32 v36, 1, v5
    v_lshrrev_b32 v36, v36, s52
    v_bfe_u32 v51, v36, 1, 1
    v_and_b32 v36, 1, v36
    v_lshl_or_b32 v51, v51, 16, v36

    s_mov_b32 s66, 0
fw_1:
    s_sleep 1
    ds_read_b32 v248, v253 offset:0
    s_add_u32 s66, s66, 1
    s_cmp_gt_u32 s66, 40000000
    s_cbranch_scc1 L_end
    s_waitcnt lgkmcnt(0)
    v_cmp_ne_u32 vcc, 1, v248
    s_cbranch_vccnz fw_1
    s_sleep 2
    s_add_u32 s78, s70, 2097152
    s_mov_b32 s66, 0
    buffer_load_dwordx4 v[64:67], v7, s[48:51], s78 offen offset:0 nt
    buffer_load_dwordx4 v[68:71], v7, s[48:51], s78 offen offset:64 nt
    buffer_load_dwordx4 v[72:75], v7, s[48:51], s78 offen offset:128 nt
    buffer_load_dwordx4 v[76:79], v7, s[48:51], s78 offen offset:192 nt
    s_waitcnt vmcnt(4)
    ds_read_b128 v[128:131], v12 offset:0
    ds_read_b128 v[144:147], v12 offset:256
    ds_read_b128 v[160:163], v12 offset:512
    ds_read_b128 v[176:179], v12 offset:768
    ds_read_b128 v[132:135], v13 offset:0
    ds_read_b128 v[148:151], v13 offset:256
    ds_read_b128 v[164:167], v13 offset:512
    ds_read_b128 v[180:183], v13 offset:768
    ds_read_b128 v[136:139], v14 offset:0
    ds_read_b128 v[152:155], v14 offset:256
    ds_read_b128 v[168:171], v14 offset:512
    ds_read_b128 v[184:187], v14 offset:768
    ds_read_b128 v[140:143], v15 offset:0
    ds_read_b128 v[156:159], v15 offset:256
    s_waitcnt lgkmcnt(9)
    ds_read_b128 v[172:175], v15 offset:512
    ds_read_b128 v[188:191], v15 offset:768
    s_branch gsc_3
gs_2:
    buffer_load_dwordx4 v[64:67], v7, s[48:51], s78 offen offset:0 nt
    buffer_load_dwordx4 v[68:71], v7, s[48:51], s78 offen offset:64 nt
    buffer_load_dwordx4 v[72:75], v7, s[48:51], s78 offen offset:128 nt
    buffer_load_dwordx4 v[76:79], v7, s[48:51], s78 offen offset:192 nt
gsc_3:
    s_waitcnt vmcnt(3)
    v_xor_b32 v248, s56, v67
    s_waitcnt vmcnt(2)
    v_bitop3_b32 v248, v248, v71, s56 bitop3:0xf6
    s_waitcnt vmcnt(1)
    v_bitop3_b32 v248, v248, v75, s56 bitop3:0xf6
    s_waitcnt vmcnt(0)
    v_bitop3_b32 v248, v248, v79, s56 bitop3:0xf6
    v_cmp_ne_u32 vcc, 0, v248
    s_cbranch_vccz gsd_5
    s_add_u32 s66, s66, 1
    s_cmp_gt_u32 s66, 2000000
    s_cbranch_scc1 L_end
    s_and_b32 s69, s66, 3
    s_cmp_lg_u32 s69, 0
    s_cbranch_scc1 gs_2
    buffer_load_dwordx4 v[64:67], v7, s[48:51], s70 offen offset:0 sc1
    buffer_load_dwordx4 v[68:71], v7, s[48:51], s70 offen offset:64 sc1
    buffer_load_dwordx4 v[72:75], v7, s[48:51], s70 offen offset:128 sc1
    buffer_load_dwordx4 v[76:79], v7, s[48:51], s70 offen offset:192 sc1
    s_branch gsc_3
gsd_5:
    ds_write_b32 v253, v254 offset:160
    v_and_b32 v66, v64, v30
    v_and_b32 v67, v65, v30
    v_and_b32 v64, v64, v31
    v_and_b32 v65, v65, v31
    v_and_b32 v70, v68, v30
    v_and_b32 v71, v69, v30
    v_and_b32 v68, v68, v31
    v_and_b32 v69, v69, v31
    v_and_b32 v74, v72, v30
    v_and_b32 v75, v73, v30
    v_and_b32 v72, v72, v31
    v_and_b32 v73, v73, v31
    v_and_b32 v78, v76, v30
    v_and_b32 v79, v77, v30
    v_and_b32 v76, v76, v31
    v_and_b32 v77, v77, v31
    s_waitcnt lgkmcnt(0)
    v_mfma_f32_16x16x32_bf16 v[80:83], v[64:67], v[128:131], 0
    v_mfma_f32_16x16x32_bf16 v[84:87], v[64:67], v[144:147], 0
    v_mfma_f32_16x16x32_bf16 v[88:91], v[64:67], v[160:163], 0
    v_mfma_f32_16x16x32_bf16 v[92:95], v[64:67], v[176:179], 0
    v_mfma_f32_16x16x32_bf16 v[80:83], v[68:71], v[132:135], v[80:83]
    v_mfma_f32_16x16x32_bf16 v[84:87], v[68:71], v[148:151], v[84:87]
    v_mfma_f32_16x16x32_bf16 v[88:91], v[68:71], v[164:167], v[88:91]
    v_mfma_f32_16x16x32_bf16 v[92:95], v[68:71], v[180:183], v[92:95]
    v_mfma_f32_16x16x32_bf16 v[80:83], v[72:75], v[136:139], v[80:83]
    v_mfma_f32_16x16x32_bf16 v[84:87], v[72:75], v[152:155], v[84:87]
    v_mfma_f32_16x16x32_bf16 v[88:91], v[72:75], v[168:171], v[88:91]
    v_mfma_f32_16x16x32_bf16 v[92:95], v[72:75], v[184:187], v[92:95]
    v_mfma_f32_16x16x32_bf16 v[80:83], v[76:79], v[140:143], v[80:83]
    v_mfma_f32_16x16x32_bf16 v[84:87], v[76:79], v[156:159], v[84:87]
    v_mfma_f32_16x16x32_bf16 v[88:91], v[76:79], v[172:175], v[88:91]
    v_mfma_f32_16x16x32_bf16 v[92:95], v[76:79], v[188:191], v[92:95]
    s_nop 4
    v_add_f32 v80, v80, v81
    v_add_f32 v82, v82, v83
    v_add_f32 v84, v84, v85
    v_add_f32 v86, v86, v87
    v_add_f32 v88, v88, v89
    v_add_f32 v90, v90, v91
    v_add_f32 v92, v92, v93
    v_add_f32 v94, v94, v95
    v_add_f32 v40, v80, v82
    v_add_f32 v41, v84, v86
    v_add_f32 v42, v88, v90
    v_add_f32 v43, v92, v94
    v_mov_b32 v44, v40
    v_mov_b32 v45, v41
    v_mov_b32 v46, v42
    v_mov_b32 v47, v43
    v_permlane16_swap_b32 v40, v44
    v_permlane16_swap_b32 v41, v45
    v_permlane16_swap_b32 v42, v46
    v_permlane16_swap_b32 v43, v47
    v_add_f32 v40, v40, v44
    v_add_f32 v41, v41, v45
    v_add_f32 v42, v42, v46
    v_add_f32 v43, v43, v47
    v_mov_b32 v44, v40
    v_mov_b32 v45, v41
    v_mov_b32 v46, v42
    v_mov_b32 v47, v43
    v_permlane32_swap_b32 v40, v44
    v_permlane32_swap_b32 v41, v45
    v_permlane32_swap_b32 v42, v46
    v_permlane32_swap_b32 v43, v47
    v_add_f32 v40, v40, v44
    v_add_f32 v41, v41, v45
    v_add_f32 v42, v42, v46
    v_add_f32 v43, v43, v47
    v_mul_f32 v40, 0x3e0293ee, v40
    v_mul_f32 v41, 0x3e0293ee, v41
    v_mul_f32 v42, 0x3e0293ee, v42
    v_mul_f32 v43, 0x3e0293ee, v43
    v_add_u32 v40, 0x10000, v40
    v_add_u32 v41, 0x10000, v41
    v_perm_b32 v48, v41, v40, s76
    v_bfi_b32 v48, s53, v50, v48
    v_add_u32 v42, 0x10000, v42
    v_add_u32 v43, 0x10000, v43
    v_perm_b32 v49, v43, v42, s76
    v_bfi_b32 v49, s53, v51, v49
    s_mov_b64 exec, 0xffff
    buffer_store_dwordx2 v[48:49], v4, s[48:51], s73 offen offset:0 sc1
    s_mov_b64 exec, -1
    ds_write_b32 v253, v254 offset:16
    s_branch L_s_qg
L_arole:
    s_load_dwordx2 s[8:9], s[0:1], 8
    s_mov_b32 s10, 0x1000000
    s_mov_b32 s11, 0x20000
    s_setprio 2
    v_mov_b32 v38, 0
    v_mov_b32 v39, 0
    v_lshlrev_b32 v36, 3, v1
    v_add_u32 v36, 147968, v36
    ds_write_b64 v36, v[38:39]
    s_lshr_b32 s70, s59, 1
    s_lshl_b32 s62, s58, 4
    s_add_u32 s62, s62, s70

    v_add_u32 v36, 0, v3
    v_and_b32 v38, 7, v36
    v_lshrrev_b32 v37, 3, v36
    v_lshl_or_b32 v37, v38, 1, v37
    v_xor_b32 v37, v2, v37
    v_lshlrev_b32 v37, 4, v37
    v_lshl_add_u32 v4, v3, 10, v37
    v_add_u32 v36, 4, v3
    v_and_b32 v38, 7, v36
    v_lshrrev_b32 v37, 3, v36
    v_lshl_or_b32 v37, v38, 1, v37
    v_xor_b32 v37, v2, v37
    v_lshlrev_b32 v37, 4, v37
    v_lshl_add_u32 v5, v3, 10, v37
    v_add_u32 v36, 8, v3
    v_and_b32 v38, 7, v36
    v_lshrrev_b32 v37, 3, v36
    v_lshl_or_b32 v37, v38, 1, v37
    v_xor_b32 v37, v2, v37
    v_lshlrev_b32 v37, 4, v37
    v_lshl_add_u32 v6, v3, 10, v37
    v_add_u32 v36, 12, v3
    v_and_b32 v38, 7, v36
    v_lshrrev_b32 v37, 3, v36
    v_lshl_or_b32 v37, v38, 1, v37
    v_xor_b32 v37, v2, v37
    v_lshlrev_b32 v37, 4, v37
    v_lshl_add_u32 v7, v3, 10, v37
    s_lshl_b32 s72, s62, 17
    s_lshl_b32 s71, s3, 15
    s_add_u32 s72, s72, s71
    s_lshl_b32 s71, s3, 13
    s_waitcnt lgkmcnt(0)
    s_load_dword s57, s[48:49], 0
    s_barrier

    s_add_u32 s73, s72, 0
    s_add_u32 m0, s71, 0
    s_nop 0
    buffer_load_dwordx4 v4, s[8:11], s73 offen nt lds
    s_add_u32 s73, s72, 4096
    s_add_u32 m0, s71, 1024
    s_nop 0
    buffer_load_dwordx4 v5, s[8:11], s73 offen nt lds
    s_add_u32 s73, s72, 8192
    s_add_u32 m0, s71, 2048
    s_nop 0
    buffer_load_dwordx4 v6, s[8:11], s73 offen nt lds
    s_add_u32 s73, s72, 12288
    s_add_u32 m0, s71, 3072
    s_nop 0
    buffer_load_dwordx4 v7, s[8:11], s73 offen nt lds
    s_mov_b32 s50, 0x10000000
    s_mov_b32 s51, 0x20000
    s_lshr_b32 s70, s59, 1
    s_lshl_b32 s62, s58, 4
    s_add_u32 s62, s62, s70
    s_and_b32 s63, s59, 1
    s_cmp_eq_u32 s63, 1
    s_cselect_b32 s54, s70, 31
    s_mul_i32 s65, s58, 7
    s_add_u32 s65, s65, s54
    s_sub_u32 s55, s54, 7
    s_mov_b32 s76, 0x07060302

    s_lshl_b32 s67, s64, 2
    s_add_u32 s67, s67, 147968
    v_mov_b32 v255, s67
    v_mov_b32 v254, 1
    v_mov_b32 v253, 147968
    v_lshlrev_b32 v29, 4, v1
    v_add_u32 v29, 148480, v29
    s_lshl_b32 s77, s3, 10
    v_add_u32 v28, s77, v29
    v_lshlrev_b32 v119, 4, v2
    v_add_u32 v119, 147456, v119
    s_lshl_b32 s77, s3, 2
    v_add_u32 v118, s77, v119
    v_mov_b32 v36, -1
    v_mov_b32 v37, -1
    v_mov_b32 v38, -1
    v_mov_b32 v39, -1
    ds_write_b32 v118, v36
    ds_write_b128 v28, v[36:39]

    ds_write_b32 v255, v254 offset:224
    s_lshl_b32 s74, s63, 21
    s_lshl_b32 s77, s3, 15
    s_add_u32 s74, s74, s77
    s_lshl_b32 s77, s62, 7
    s_add_u32 s74, s74, s77
    s_add_u32 s74, s74, 16777216
    v_lshrrev_b32 v117, 3, v2
    v_lshlrev_b32 v117, 14, v117
    v_lshl_add_u32 v117, v3, 19, v117
    v_and_b32 v116, 7, v2
    v_lshl_add_u32 v117, v116, 4, v117
    s_lshl_b32 s75, s63, 15
    s_lshl_b32 s77, s62, 8
    s_add_u32 s75, s75, s77
    s_add_u32 s75, s75, 589824
    v_lshlrev_b32 v116, 4, v2

    v_and_b32 v37, 7, v2
    v_lshrrev_b32 v36, 3, v2
    v_lshl_or_b32 v36, v37, 1, v36
    v_lshl_add_u32 v37, v3, 2, 0
    v_xor_b32 v37, v37, v36
    v_lshlrev_b32 v37, 4, v37
    v_lshl_add_u32 v38, v2, 8, v37
    v_add_u32 v8, s71, v38
    v_add_u32 v12, 0x10000, v8
    v_lshl_add_u32 v38, v2, 10, v37
    v_add_u32 v16, 131072, v38

    v_lshl_add_u32 v37, v3, 2, 1
    v_xor_b32 v37, v37, v36
    v_lshlrev_b32 v37, 4, v37
    v_lshl_add_u32 v38, v2, 8, v37
    v_add_u32 v9, s71, v38
    v_add_u32 v13, 0x10000, v9
    v_lshl_add_u32 v38, v2, 10, v37
    v_add_u32 v17, 131072, v38

    v_lshl_add_u32 v37, v3, 2, 2
    v_xor_b32 v37, v37, v36
    v_lshlrev_b32 v37, 4, v37
    v_lshl_add_u32 v38, v2, 8, v37
    v_add_u32 v10, s71, v38
    v_add_u32 v14, 0x10000, v10
    v_lshl_add_u32 v38, v2, 10, v37
    v_add_u32 v18, 131072, v38

    v_lshl_add_u32 v37, v3, 2, 3
    v_xor_b32 v37, v37, v36
    v_lshlrev_b32 v37, 4, v37
    v_lshl_add_u32 v38, v2, 8, v37
    v_add_u32 v11, s71, v38
    v_add_u32 v15, 0x10000, v11
    v_lshl_add_u32 v38, v2, 10, v37
    v_add_u32 v19, 131072, v38

    v_lshrrev_b32 v36, 2, v1
    v_and_b32 v38, 7, v36
    v_lshrrev_b32 v37, 3, v36
    v_lshl_or_b32 v37, v38, 1, v37
    v_bfe_u32 v38, v1, 1, 1
    v_and_b32 v39, 1, v1
    v_lshlrev_b32 v39, 3, v39
    v_lshl_add_u32 v39, v36, 8, v39
    s_lshl_b32 s77, s3, 15
    v_add_u32 v39, s77, v39

    v_add_u32 v36, 0, v38
    v_xor_b32 v36, v36, v37
    v_lshl_add_u32 v20, v36, 4, v39
    v_add_u32 v36, 2, v38
    v_xor_b32 v36, v36, v37
    v_lshl_add_u32 v21, v36, 4, v39
    v_add_u32 v36, 4, v38
    v_xor_b32 v36, v36, v37
    v_lshl_add_u32 v22, v36, 4, v39
    v_add_u32 v36, 6, v38
    v_xor_b32 v36, v36, v37
    v_lshl_add_u32 v23, v36, 4, v39
    v_add_u32 v36, 8, v38
    v_xor_b32 v36, v36, v37
    v_lshl_add_u32 v24, v36, 4, v39
    v_add_u32 v36, 10, v38
    v_xor_b32 v36, v36, v37
    v_lshl_add_u32 v25, v36, 4, v39
    v_add_u32 v36, 12, v38
    v_xor_b32 v36, v36, v37
    v_lshl_add_u32 v26, v36, 4, v39
    v_add_u32 v36, 14, v38
    v_xor_b32 v36, v36, v37
    v_lshl_add_u32 v27, v36, 4, v39
    v_mov_b32 v32, 0x3f803f80
    v_mov_b32 v33, 0x3f803f80
    v_mov_b32 v34, 0x3f803f80
    v_mov_b32 v35, 0x3f803f80
    s_waitcnt lgkmcnt(0)
    s_add_u32 s57, s57, 1
    s_and_b32 s56, s57, 0x3fff
    s_lshl_b32 s67, s57, 2
    s_and_b32 s67, s67, 0x3fff0000
    s_or_b32 s56, s56, s67
    s_and_b32 s52, s57, 0xff
    s_mul_i32 s67, s52, 0x01000100
    s_and_b32 s68, s57, 0xff00ff00
    s_add_u32 s67, s67, s68
    s_and_b32 s67, s67, 0xff00ff00
    s_or_b32 s69, s52, s67
    s_lshl_b32 s67, s52, 16
    s_add_u32 s67, s67, s57
    s_and_b32 s67, s67, 0x00ff0000
    s_or_b32 s52, s69, s67
    s_mov_b32 s53, 0x00010001
    v_and_b32 v36, 3, v1
    v_lshlrev_b32 v36, 3, v36
    v_lshrrev_b32 v37, v36, s52
    v_bfe_u32 v112, v37, 0, 1
    v_bfe_u32 v36, v37, 1, 1
    v_lshl_or_b32 v112, v36, 16, v112
    v_bfe_u32 v113, v37, 2, 1
    v_bfe_u32 v36, v37, 3, 1
    v_lshl_or_b32 v113, v36, 16, v113
    v_bfe_u32 v114, v37, 4, 1
    v_bfe_u32 v36, v37, 5, 1
    v_lshl_or_b32 v114, v36, 16, v114
    v_bfe_u32 v115, v37, 6, 1
    v_bfe_u32 v36, v37, 7, 1
    v_lshl_or_b32 v115, v36, 16, v115
    s_mov_b32 s66, 0
fw_6:
    s_sleep 1
    ds_read_b128 v[248:251], v253 offset:224
    s_add_u32 s66, s66, 1
    s_cmp_gt_u32 s66, 40000000
    s_cbranch_scc1 L_end
    s_waitcnt lgkmcnt(0)
    v_and_b32 v248, v248, v249
    v_bitop3_b32 v248, v248, v250, v251 bitop3:0x80
    v_cmp_ne_u32 vcc, 1, v248
    s_cbranch_vccnz fw_6
    s_mov_b32 s66, 0
fw_7:
    s_sleep 1
    ds_read_b32 v248, v253 offset:160
    s_add_u32 s66, s66, 1
    s_cmp_gt_u32 s66, 40000000
    s_cbranch_scc1 L_end
    s_waitcnt lgkmcnt(0)
    v_cmp_ne_u32 vcc, 1, v248
    s_cbranch_vccnz fw_7
    s_add_u32 s73, s72, 16384
    s_add_u32 m0, s71, 4096
    s_nop 0
    buffer_load_dwordx4 v4, s[8:11], s73 offen nt lds
    s_add_u32 s73, s72, 20480
    s_add_u32 m0, s71, 5120
    s_nop 0
    buffer_load_dwordx4 v5, s[8:11], s73 offen nt lds
    s_add_u32 s73, s72, 24576
    s_add_u32 m0, s71, 6144
    s_nop 0
    buffer_load_dwordx4 v6, s[8:11], s73 offen nt lds
    s_add_u32 s73, s72, 28672
    s_add_u32 m0, s71, 7168
    s_nop 0
    buffer_load_dwordx4 v7, s[8:11], s73 offen nt lds
    s_add_u32 s73, s72, 256
    s_add_u32 m0, s71, 32768
    s_nop 0
    buffer_load_dwordx4 v4, s[8:11], s73 offen nt lds
    s_add_u32 s73, s72, 4352
    s_add_u32 m0, s71, 33792
    s_nop 0
    buffer_load_dwordx4 v5, s[8:11], s73 offen nt lds
    s_mov_b32 s66, 0
fw_8:
    s_sleep 1
    ds_read_b128 v[248:251], v253 offset:176
    s_add_u32 s66, s66, 1
    s_cmp_gt_u32 s66, 40000000
    s_cbranch_scc1 L_end
    s_waitcnt lgkmcnt(0)
    v_and_b32 v248, v248, v249
    v_bitop3_b32 v248, v248, v250, v251 bitop3:0x80
    v_cmp_ne_u32 vcc, 1, v248
    s_cbranch_vccnz fw_8
    s_add_u32 s73, s72, 8448
    s_add_u32 m0, s71, 34816
    s_nop 0
    buffer_load_dwordx4 v6, s[8:11], s73 offen nt lds
    s_add_u32 s73, s72, 12544
    s_add_u32 m0, s71, 35840
    s_nop 0
    buffer_load_dwordx4 v7, s[8:11], s73 offen nt lds
    s_add_u32 s73, s72, 16640
    s_add_u32 m0, s71, 36864
    s_nop 0
    buffer_load_dwordx4 v4, s[8:11], s73 offen nt lds
    s_add_u32 s73, s72, 20736
    s_add_u32 m0, s71, 37888
    s_nop 0
    buffer_load_dwordx4 v5, s[8:11], s73 offen nt lds
    s_add_u32 s73, s72, 24832
    s_add_u32 m0, s71, 38912
    s_nop 0
    buffer_load_dwordx4 v6, s[8:11], s73 offen nt lds
    s_add_u32 s73, s72, 28928
    s_add_u32 m0, s71, 39936
    s_nop 0
    buffer_load_dwordx4 v7, s[8:11], s73 offen nt lds
    s_add_u32 s73, s72, 512
    s_add_u32 m0, s71, 65536
    s_nop 0
    buffer_load_dwordx4 v4, s[8:11], s73 offen nt lds
    s_add_u32 s73, s72, 4608
    s_add_u32 m0, s71, 66560
    s_nop 0
    buffer_load_dwordx4 v5, s[8:11], s73 offen nt lds
    s_add_u32 s73, s72, 8704
    s_add_u32 m0, s71, 67584
    s_nop 0
    buffer_load_dwordx4 v6, s[8:11], s73 offen nt lds
    s_add_u32 s73, s72, 12800
    s_add_u32 m0, s71, 68608
    s_nop 0
    buffer_load_dwordx4 v7, s[8:11], s73 offen nt lds
    s_add_u32 s73, s72, 16896
    s_add_u32 m0, s71, 69632
    s_nop 0
    buffer_load_dwordx4 v4, s[8:11], s73 offen nt lds
    s_add_u32 s73, s72, 20992
    s_add_u32 m0, s71, 70656
    s_nop 0
    buffer_load_dwordx4 v5, s[8:11], s73 offen nt lds
    s_add_u32 s73, s72, 25088
    s_add_u32 m0, s71, 71680
    s_nop 0
    buffer_load_dwordx4 v6, s[8:11], s73 offen nt lds
    s_add_u32 s73, s72, 29184
    s_add_u32 m0, s71, 72704
    s_nop 0
    buffer_load_dwordx4 v7, s[8:11], s73 offen nt lds
    s_add_u32 s73, s72, 768
    s_add_u32 m0, s71, 98304
    s_nop 0
    buffer_load_dwordx4 v4, s[8:11], s73 offen nt lds
    s_add_u32 s73, s72, 4864
    s_add_u32 m0, s71, 99328
    s_nop 0
    buffer_load_dwordx4 v5, s[8:11], s73 offen nt lds
    s_add_u32 s73, s72, 8960
    s_add_u32 m0, s71, 100352
    s_nop 0
    buffer_load_dwordx4 v6, s[8:11], s73 offen nt lds
    s_add_u32 s73, s72, 13056
    s_add_u32 m0, s71, 101376
    s_nop 0
    buffer_load_dwordx4 v7, s[8:11], s73 offen nt lds
    s_add_u32 s73, s72, 17152
    s_add_u32 m0, s71, 102400
    s_nop 0
    buffer_load_dwordx4 v4, s[8:11], s73 offen nt lds
    s_add_u32 s73, s72, 21248
    s_add_u32 m0, s71, 103424
    s_nop 0
    buffer_load_dwordx4 v5, s[8:11], s73 offen nt lds
    s_add_u32 s73, s72, 25344
    s_add_u32 m0, s71, 104448
    s_nop 0
    buffer_load_dwordx4 v6, s[8:11], s73 offen nt lds
    s_add_u32 s73, s72, 29440
    s_add_u32 m0, s71, 105472
    s_nop 0
    buffer_load_dwordx4 v7, s[8:11], s73 offen nt lds
    ds_write_b32 v255, v254 offset:192
    s_waitcnt vmcnt(24)
    ds_read_b128 v[184:187], v8 offset:0
    ds_read_b128 v[200:203], v8 offset:4096
    ds_read_b128 v[188:191], v9 offset:0
    ds_read_b128 v[204:207], v9 offset:4096
    ds_read_b128 v[192:195], v10 offset:0
    ds_read_b128 v[208:211], v10 offset:4096
    ds_read_b128 v[196:199], v11 offset:0
    ds_read_b128 v[212:215], v11 offset:4096
    s_waitcnt lgkmcnt(0)
    s_mov_b32 s66, 0
fw_9:
    s_waitcnt lgkmcnt(2)
    ds_read_b128 v[248:251], v253 offset:32
    ds_read_b128 v[120:123], v16 offset:0
    ds_read_b128 v[124:127], v17 offset:0
    ds_read_b128 v[128:131], v18 offset:0
    ds_read_b128 v[132:135], v19 offset:0
    ds_read_b128 v[136:139], v16 offset:256
    ds_read_b128 v[140:143], v17 offset:256
    ds_read_b128 v[144:147], v18 offset:256
    ds_read_b128 v[148:151], v19 offset:256
    s_add_u32 s66, s66, 1
    s_cmp_gt_u32 s66, 40000000
    s_cbranch_scc1 L_end
    s_waitcnt lgkmcnt(8)
    v_and_b32 v248, v248, v249
    v_bitop3_b32 v248, v248, v250, v251 bitop3:0x80
    v_cmp_ne_u32 vcc, 1, v248
    s_cbranch_vccnz fw_9
    s_waitcnt vmcnt(16)
    ds_read_b128 v[216:219], v8 offset:32768
    ds_read_b128 v[232:235], v8 offset:36864
    ds_read_b128 v[220:223], v9 offset:32768
    ds_read_b128 v[236:239], v9 offset:36864
    ds_read_b128 v[224:227], v10 offset:32768
    ds_read_b128 v[240:243], v10 offset:36864
    s_waitcnt lgkmcnt(9)
    ds_read_b128 v[228:231], v11 offset:32768
    ds_read_b128 v[244:247], v11 offset:36864
    v_mfma_f32_16x16x32_bf16 v[40:43], v[184:187], v[120:123], 0
    v_mfma_f32_16x16x32_bf16 v[44:47], v[200:203], v[120:123], 0
    ds_read_b128 v[152:155], v16 offset:512
    v_mfma_f32_16x16x32_bf16 v[40:43], v[188:191], v[124:127], v[40:43]
    v_mfma_f32_16x16x32_bf16 v[44:47], v[204:207], v[124:127], v[44:47]
    ds_read_b128 v[156:159], v17 offset:512
    v_mfma_f32_16x16x32_bf16 v[40:43], v[192:195], v[128:131], v[40:43]
    v_mfma_f32_16x16x32_bf16 v[44:47], v[208:211], v[128:131], v[44:47]
    ds_read_b128 v[160:163], v18 offset:512
    v_mfma_f32_16x16x32_bf16 v[40:43], v[196:199], v[132:135], v[40:43]
    v_mfma_f32_16x16x32_bf16 v[44:47], v[212:215], v[132:135], v[44:47]
    s_waitcnt lgkmcnt(9)
    ds_read_b128 v[164:167], v19 offset:512
    s_waitcnt vmcnt(8)
    ds_read_b128 v[184:187], v12 offset:0
    ds_read_b128 v[200:203], v12 offset:4096
    ds_read_b128 v[188:191], v13 offset:0
    ds_read_b128 v[204:207], v13 offset:4096
    s_waitcnt lgkmcnt(9)
    ds_read_b128 v[192:195], v14 offset:0
    ds_read_b128 v[208:211], v14 offset:4096
    ds_read_b128 v[196:199], v15 offset:0
    ds_read_b128 v[212:215], v15 offset:4096
    v_mfma_f32_16x16x32_bf16 v[40:43], v[216:219], v[136:139], v[40:43]
    v_mfma_f32_16x16x32_bf16 v[44:47], v[232:235], v[136:139], v[44:47]
    ds_read_b128 v[168:171], v16 offset:768
    v_mfma_f32_16x16x32_bf16 v[40:43], v[220:223], v[140:143], v[40:43]
    v_mfma_f32_16x16x32_bf16 v[44:47], v[236:239], v[140:143], v[44:47]
    s_waitcnt lgkmcnt(9)
    ds_read_b128 v[172:175], v17 offset:768
    v_mfma_f32_16x16x32_bf16 v[40:43], v[224:227], v[144:147], v[40:43]
    v_mfma_f32_16x16x32_bf16 v[44:47], v[240:243], v[144:147], v[44:47]
    ds_read_b128 v[176:179], v18 offset:768
    v_mfma_f32_16x16x32_bf16 v[40:43], v[228:231], v[148:151], v[40:43]
    v_mfma_f32_16x16x32_bf16 v[44:47], v[244:247], v[148:151], v[44:47]
    ds_read_b128 v[180:183], v19 offset:768
    s_waitcnt lgkmcnt(11)
    v_mfma_f32_16x16x32_bf16 v[40:43], v[184:187], v[152:155], v[40:43]
    s_waitcnt lgkmcnt(10)
    v_mfma_f32_16x16x32_bf16 v[44:47], v[200:203], v[152:155], v[44:47]
    s_waitcnt lgkmcnt(9)
    v_mfma_f32_16x16x32_bf16 v[40:43], v[188:191], v[156:159], v[40:43]
    s_waitcnt lgkmcnt(8)
    v_mfma_f32_16x16x32_bf16 v[44:47], v[204:207], v[156:159], v[44:47]
    s_waitcnt lgkmcnt(7)
    v_mfma_f32_16x16x32_bf16 v[40:43], v[192:195], v[160:163], v[40:43]
    s_waitcnt lgkmcnt(6)
    v_mfma_f32_16x16x32_bf16 v[44:47], v[208:211], v[160:163], v[44:47]
    s_waitcnt lgkmcnt(5)
    v_mfma_f32_16x16x32_bf16 v[40:43], v[196:199], v[164:167], v[40:43]
    s_waitcnt lgkmcnt(4)
    v_mfma_f32_16x16x32_bf16 v[44:47], v[212:215], v[164:167], v[44:47]
    s_waitcnt vmcnt(0)
    ds_write_b32 v255, v254 offset:288
    ds_read_b128 v[216:219], v12 offset:32768
    ds_read_b128 v[232:235], v12 offset:36864
    ds_read_b128 v[220:223], v13 offset:32768
    ds_read_b128 v[236:239], v13 offset:36864
    ds_read_b128 v[224:227], v14 offset:32768
    ds_read_b128 v[240:243], v14 offset:36864
    ds_read_b128 v[228:231], v15 offset:32768
    ds_read_b128 v[244:247], v15 offset:36864
    s_waitcnt lgkmcnt(12)
    s_waitcnt lgkmcnt(7)
    v_mfma_f32_16x16x32_bf16 v[40:43], v[216:219], v[168:171], v[40:43]
    s_waitcnt lgkmcnt(6)
    v_mfma_f32_16x16x32_bf16 v[44:47], v[232:235], v[168:171], v[44:47]
    s_waitcnt lgkmcnt(5)
    v_mfma_f32_16x16x32_bf16 v[40:43], v[220:223], v[172:175], v[40:43]
    s_waitcnt lgkmcnt(4)
    v_mfma_f32_16x16x32_bf16 v[44:47], v[236:239], v[172:175], v[44:47]
    s_waitcnt lgkmcnt(3)
    v_mfma_f32_16x16x32_bf16 v[40:43], v[224:227], v[176:179], v[40:43]
    s_waitcnt lgkmcnt(2)
    v_mfma_f32_16x16x32_bf16 v[44:47], v[240:243], v[176:179], v[44:47]
    s_waitcnt lgkmcnt(1)
    v_mfma_f32_16x16x32_bf16 v[40:43], v[228:231], v[180:183], v[40:43]
    s_waitcnt lgkmcnt(0)
    v_mfma_f32_16x16x32_bf16 v[44:47], v[244:247], v[180:183], v[44:47]
    s_mov_b32 s66, 0
fw_10:
    s_waitcnt lgkmcnt(2)
    ds_read_b128 v[248:251], v253 offset:288
    ds_read_b64_tr_b16 v[120:121], v20 offset:0
    ds_read_b64_tr_b16 v[122:123], v20 offset:4096
    ds_read_b64_tr_b16 v[136:137], v21 offset:0
    ds_read_b64_tr_b16 v[138:139], v21 offset:4096
    ds_read_b64_tr_b16 v[152:153], v22 offset:0
    ds_read_b64_tr_b16 v[154:155], v22 offset:4096
    ds_read_b64_tr_b16 v[168:169], v23 offset:0
    ds_read_b64_tr_b16 v[170:171], v23 offset:4096
    s_add_u32 s66, s66, 1
    s_cmp_gt_u32 s66, 40000000
    s_cbranch_scc1 L_end
    s_waitcnt lgkmcnt(8)
    v_and_b32 v248, v248, v249
    v_bitop3_b32 v248, v248, v250, v251 bitop3:0x80
    v_cmp_ne_u32 vcc, 1, v248
    s_cbranch_vccnz fw_10
    v_max3_f32 v36, v40, v41, v42
    v_max3_f32 v37, v43, v44, v45
    v_max3_f32 v36, v36, v46, v47
    v_max_f32 v36, v36, v37
    v_mov_b32 v37, v36
    ds_read_b64_tr_b16 v[124:125], v20 offset:8192
    ds_read_b64_tr_b16 v[126:127], v20 offset:12288
    v_permlane16_swap_b32 v36, v37
    v_max_f32 v36, v36, v37
    v_mov_b32 v37, v36
    ds_read_b64_tr_b16 v[140:141], v21 offset:8192
    ds_read_b64_tr_b16 v[142:143], v21 offset:12288
    v_permlane32_swap_b32 v36, v37
    v_max_f32 v36, v36, v37
    v_ceil_f32 v36, v36
    v_sub_f32 v40, v40, v36
    v_sub_f32 v41, v41, v36
    v_sub_f32 v42, v42, v36
    v_sub_f32 v43, v43, v36
    v_sub_f32 v44, v44, v36
    v_sub_f32 v45, v45, v36
    v_sub_f32 v46, v46, v36
    v_sub_f32 v47, v47, v36
    v_exp_f32 v40, v40
    ds_read_b64_tr_b16 v[156:157], v22 offset:8192
    v_exp_f32 v41, v41
    ds_read_b64_tr_b16 v[158:159], v22 offset:12288
    v_exp_f32 v42, v42
    s_waitcnt lgkmcnt(9)
    ds_read_b64_tr_b16 v[172:173], v23 offset:8192
    v_exp_f32 v43, v43
    ds_read_b64_tr_b16 v[174:175], v23 offset:12288
    v_exp_f32 v44, v44
    ds_read_b64_tr_b16 v[128:129], v20 offset:16384
    v_exp_f32 v45, v45
    ds_read_b64_tr_b16 v[130:131], v20 offset:20480
    v_exp_f32 v46, v46
    ds_read_b64_tr_b16 v[144:145], v21 offset:16384
    v_exp_f32 v47, v47
    s_waitcnt lgkmcnt(9)
    ds_read_b64_tr_b16 v[146:147], v21 offset:20480
    v_cvt_pk_bf16_f32 v48, v40, v41
    v_cvt_pk_bf16_f32 v49, v42, v43
    v_cvt_pk_bf16_f32 v50, v44, v45
    v_cvt_pk_bf16_f32 v51, v46, v47
    ds_write_b128 v28, v[48:51]
    ds_write_b32 v118, v36
    ds_read_b64_tr_b16 v[160:161], v22 offset:16384
    ds_read_b64_tr_b16 v[162:163], v22 offset:20480
    s_waitcnt lgkmcnt(9)
    ds_read_b64_tr_b16 v[176:177], v23 offset:16384
    ds_read_b64_tr_b16 v[178:179], v23 offset:20480
    ds_read_b64_tr_b16 v[132:133], v20 offset:24576
    ds_read_b64_tr_b16 v[134:135], v20 offset:28672
    s_mov_b32 s66, 0
L_a_p:
    s_waitcnt lgkmcnt(8)
    ds_read_b128 v[36:39], v119
    ds_read_b128 v[48:51], v29 offset:0
    ds_read_b128 v[52:55], v29 offset:1024
    ds_read_b128 v[56:59], v29 offset:2048
    ds_read_b128 v[60:63], v29 offset:3072
    s_add_u32 s66, s66, 1
    s_cmp_gt_u32 s66, 40000000
    s_cbranch_scc1 L_end
    s_waitcnt lgkmcnt(4)
    v_max3_u32 v248, v36, v37, v38
    v_max_u32 v248, v248, v39
    v_cmp_eq_u32 vcc, -1, v248
    s_cbranch_vccnz L_a_p

    v_max3_f32 v40, v36, v37, v38
    v_max_f32 v40, v40, v39
    v_sub_f32 v44, v40, v36
    v_cvt_u32_f32 v44, v44
    v_min_u32 v44, 0xff, v44
    v_mul_u32_u24 v44, 0x800080, v44
    s_waitcnt lgkmcnt(3)
    v_pk_sub_u16 v48, v48, v44 clamp
    v_pk_sub_u16 v49, v49, v44 clamp
    v_pk_sub_u16 v50, v50, v44 clamp
    v_pk_sub_u16 v51, v51, v44 clamp
    s_nop 1
    v_mfma_f32_16x16x32_bf16 v[64:67], v[32:35], v[48:51], 0
    ds_read_b64_tr_b16 v[148:149], v21 offset:24576
    ds_read_b64_tr_b16 v[150:151], v21 offset:28672
    v_sub_f32 v45, v40, v37
    v_cvt_u32_f32 v45, v45
    v_mfma_f32_16x16x32_bf16 v[68:71], v[48:51], v[120:123], 0
    ds_read_b64_tr_b16 v[164:165], v22 offset:24576
    ds_read_b64_tr_b16 v[166:167], v22 offset:28672
    v_min_u32 v45, 0xff, v45
    v_mul_u32_u24 v45, 0x800080, v45
    v_mfma_f32_16x16x32_bf16 v[72:75], v[48:51], v[136:139], 0
    ds_read_b64_tr_b16 v[180:181], v23 offset:24576
    ds_read_b64_tr_b16 v[182:183], v23 offset:28672
    s_waitcnt lgkmcnt(8)
    v_pk_sub_u16 v52, v52, v45 clamp
    v_mfma_f32_16x16x32_bf16 v[76:79], v[48:51], v[152:155], 0
    ds_read_b64_tr_b16 v[184:185], v24 offset:0
    ds_read_b64_tr_b16 v[186:187], v24 offset:4096
    v_pk_sub_u16 v53, v53, v45 clamp
    v_pk_sub_u16 v54, v54, v45 clamp
    v_mfma_f32_16x16x32_bf16 v[80:83], v[48:51], v[168:171], 0
    ds_read_b64_tr_b16 v[188:189], v24 offset:8192
    ds_read_b64_tr_b16 v[190:191], v24 offset:12288
    v_pk_sub_u16 v55, v55, v45 clamp
    s_nop 1
    v_mfma_f32_16x16x32_bf16 v[64:67], v[32:35], v[52:55], v[64:67]
    ds_read_b64_tr_b16 v[192:193], v24 offset:16384
    ds_read_b64_tr_b16 v[194:195], v24 offset:20480
    v_sub_f32 v46, v40, v38
    v_cvt_u32_f32 v46, v46
    v_mfma_f32_16x16x32_bf16 v[68:71], v[52:55], v[124:127], v[68:71]
    s_waitcnt lgkmcnt(9)
    ds_read_b64_tr_b16 v[196:197], v24 offset:24576
    ds_read_b64_tr_b16 v[198:199], v24 offset:28672
    v_min_u32 v46, 0xff, v46
    v_mul_u32_u24 v46, 0x800080, v46
    v_mfma_f32_16x16x32_bf16 v[72:75], v[52:55], v[140:143], v[72:75]
    ds_read_b64_tr_b16 v[200:201], v25 offset:0
    ds_read_b64_tr_b16 v[202:203], v25 offset:4096
    v_pk_sub_u16 v56, v56, v46 clamp
    v_mfma_f32_16x16x32_bf16 v[76:79], v[52:55], v[156:159], v[76:79]
    ds_read_b64_tr_b16 v[204:205], v25 offset:8192
    s_waitcnt lgkmcnt(9)
    ds_read_b64_tr_b16 v[206:207], v25 offset:12288
    v_pk_sub_u16 v57, v57, v46 clamp
    v_pk_sub_u16 v58, v58, v46 clamp
    v_mfma_f32_16x16x32_bf16 v[80:83], v[52:55], v[172:175], v[80:83]
    ds_read_b64_tr_b16 v[208:209], v25 offset:16384
    ds_read_b64_tr_b16 v[210:211], v25 offset:20480
    v_pk_sub_u16 v59, v59, v46 clamp
    s_nop 1
    v_mfma_f32_16x16x32_bf16 v[64:67], v[32:35], v[56:59], v[64:67]
    ds_read_b64_tr_b16 v[212:213], v25 offset:24576
    ds_read_b64_tr_b16 v[214:215], v25 offset:28672
    v_sub_f32 v47, v40, v39
    v_cvt_u32_f32 v47, v47
    v_mfma_f32_16x16x32_bf16 v[68:71], v[56:59], v[128:131], v[68:71]
    s_waitcnt lgkmcnt(9)
    ds_read_b64_tr_b16 v[216:217], v26 offset:0
    ds_read_b64_tr_b16 v[218:219], v26 offset:4096
    v_min_u32 v47, 0xff, v47
    v_mul_u32_u24 v47, 0x800080, v47
    v_mfma_f32_16x16x32_bf16 v[72:75], v[56:59], v[144:147], v[72:75]
    ds_read_b64_tr_b16 v[220:221], v26 offset:8192
    ds_read_b64_tr_b16 v[222:223], v26 offset:12288
    v_pk_sub_u16 v60, v60, v47 clamp
    v_mfma_f32_16x16x32_bf16 v[76:79], v[56:59], v[160:163], v[76:79]
    ds_read_b64_tr_b16 v[224:225], v26 offset:16384
    s_waitcnt lgkmcnt(9)
    ds_read_b64_tr_b16 v[226:227], v26 offset:20480
    v_pk_sub_u16 v61, v61, v47 clamp
    v_pk_sub_u16 v62, v62, v47 clamp
    v_mfma_f32_16x16x32_bf16 v[80:83], v[56:59], v[176:179], v[80:83]
    ds_read_b64_tr_b16 v[228:229], v26 offset:24576
    ds_read_b64_tr_b16 v[230:231], v26 offset:28672
    v_pk_sub_u16 v63, v63, v47 clamp
    s_nop 1
    v_mfma_f32_16x16x32_bf16 v[64:67], v[32:35], v[60:63], v[64:67]
    ds_read_b64_tr_b16 v[232:233], v27 offset:0
    ds_read_b64_tr_b16 v[234:235], v27 offset:4096
    v_mfma_f32_16x16x32_bf16 v[68:71], v[60:63], v[132:135], v[68:71]
    s_waitcnt lgkmcnt(9)
    ds_read_b64_tr_b16 v[236:237], v27 offset:8192
    ds_read_b64_tr_b16 v[238:239], v27 offset:12288
    v_mfma_f32_16x16x32_bf16 v[72:75], v[60:63], v[148:151], v[72:75]
    ds_read_b64_tr_b16 v[240:241], v27 offset:16384
    ds_read_b64_tr_b16 v[242:243], v27 offset:20480
    v_mfma_f32_16x16x32_bf16 v[76:79], v[60:63], v[164:167], v[76:79]
    ds_read_b64_tr_b16 v[244:245], v27 offset:24576
    s_waitcnt lgkmcnt(9)
    ds_read_b64_tr_b16 v[246:247], v27 offset:28672
    v_mfma_f32_16x16x32_bf16 v[80:83], v[60:63], v[180:183], v[80:83]
    v_mfma_f32_16x16x32_bf16 v[84:87], v[48:51], v[184:187], 0
    v_mfma_f32_16x16x32_bf16 v[84:87], v[52:55], v[188:191], v[84:87]
    v_mov_b32 v41, v64
    v_mov_b32 v42, 0
    v_mov_b32 v43, s56
    s_cmp_lg_u32 s64, 0
    s_cbranch_scc1 L_a_nostat
    s_mov_b64 exec, 0xffff
    buffer_store_dwordx4 v[40:43], v116, s[48:51], s75 offen sc1
    s_mov_b64 exec, -1
L_a_nostat:
    v_mfma_f32_16x16x32_bf16 v[84:87], v[56:59], v[192:195], v[84:87]
    v_add_u32 v68, 0x10000, v68
    v_add_u32 v72, 0x10000, v72
    v_perm_b32 v100, v72, v68, s76
    v_mfma_f32_16x16x32_bf16 v[84:87], v[60:63], v[196:199], v[84:87]
    v_bfi_b32 v100, s53, v112, v100
    v_add_u32 v69, 0x10000, v69
    v_add_u32 v73, 0x10000, v73
    v_mfma_f32_16x16x32_bf16 v[88:91], v[48:51], v[200:203], 0
    v_perm_b32 v104, v73, v69, s76
    v_bfi_b32 v104, s53, v112, v104
    v_add_u32 v70, 0x10000, v70
    v_mfma_f32_16x16x32_bf16 v[88:91], v[52:55], v[204:207], v[88:91]
    v_add_u32 v74, 0x10000, v74
    v_perm_b32 v108, v74, v70, s76
    v_bfi_b32 v108, s53, v112, v108
    v_mfma_f32_16x16x32_bf16 v[88:91], v[56:59], v[208:211], v[88:91]
    v_add_u32 v71, 0x10000, v71
    v_add_u32 v75, 0x10000, v75
    v_perm_b32 v4, v75, v71, s76
    v_mfma_f32_16x16x32_bf16 v[88:91], v[60:63], v[212:215], v[88:91]
    v_bfi_b32 v4, s53, v112, v4
    v_add_u32 v76, 0x10000, v76
    v_add_u32 v80, 0x10000, v80
    v_mfma_f32_16x16x32_bf16 v[92:95], v[48:51], v[216:219], 0
    v_perm_b32 v101, v80, v76, s76
    v_bfi_b32 v101, s53, v113, v101
    v_add_u32 v77, 0x10000, v77
    v_mfma_f32_16x16x32_bf16 v[92:95], v[52:55], v[220:223], v[92:95]
    v_add_u32 v81, 0x10000, v81
    v_perm_b32 v105, v81, v77, s76
    v_bfi_b32 v105, s53, v113, v105
    v_mfma_f32_16x16x32_bf16 v[92:95], v[56:59], v[224:227], v[92:95]
    v_add_u32 v78, 0x10000, v78
    v_add_u32 v82, 0x10000, v82
    v_perm_b32 v109, v82, v78, s76
    s_waitcnt lgkmcnt(8)
    v_mfma_f32_16x16x32_bf16 v[92:95], v[60:63], v[228:231], v[92:95]
    v_bfi_b32 v109, s53, v113, v109
    v_add_u32 v79, 0x10000, v79
    v_add_u32 v83, 0x10000, v83
    s_waitcnt lgkmcnt(6)
    v_mfma_f32_16x16x32_bf16 v[96:99], v[48:51], v[232:235], 0
    v_perm_b32 v5, v83, v79, s76
    v_bfi_b32 v5, s53, v113, v5
    v_add_u32 v84, 0x10000, v84
    s_waitcnt lgkmcnt(4)
    v_mfma_f32_16x16x32_bf16 v[96:99], v[52:55], v[236:239], v[96:99]
    v_add_u32 v88, 0x10000, v88
    v_perm_b32 v102, v88, v84, s76
    v_bfi_b32 v102, s53, v114, v102
    s_waitcnt lgkmcnt(2)
    v_mfma_f32_16x16x32_bf16 v[96:99], v[56:59], v[240:243], v[96:99]
    v_add_u32 v85, 0x10000, v85
    v_add_u32 v89, 0x10000, v89
    v_perm_b32 v106, v89, v85, s76
    s_waitcnt lgkmcnt(0)
    v_mfma_f32_16x16x32_bf16 v[96:99], v[60:63], v[244:247], v[96:99]
    v_bfi_b32 v106, s53, v114, v106
    v_add_u32 v86, 0x10000, v86
    v_add_u32 v90, 0x10000, v90
    v_perm_b32 v110, v90, v86, s76
    v_bfi_b32 v110, s53, v114, v110
    v_add_u32 v87, 0x10000, v87
    v_add_u32 v91, 0x10000, v91
    v_perm_b32 v6, v91, v87, s76
    v_bfi_b32 v6, s53, v114, v6
    v_add_u32 v92, 0x10000, v92
    v_add_u32 v93, 0x10000, v93
    v_add_u32 v94, 0x10000, v94
    v_add_u32 v95, 0x10000, v95
    v_add_u32 v96, 0x10000, v96
    v_perm_b32 v103, v96, v92, s76
    v_bfi_b32 v103, s53, v115, v103
    buffer_store_dwordx4 v[100:103], v117, s[48:51], s74 offen sc1
    s_add_u32 s74, s74, 0x20000
    v_add_u32 v97, 0x10000, v97
    v_perm_b32 v107, v97, v93, s76
    v_bfi_b32 v107, s53, v115, v107
    buffer_store_dwordx4 v[104:107], v117, s[48:51], s74 offen sc1
    s_add_u32 s74, s74, 0x20000
    v_add_u32 v98, 0x10000, v98
    v_perm_b32 v111, v98, v94, s76
    v_bfi_b32 v111, s53, v115, v111
    buffer_store_dwordx4 v[108:111], v117, s[48:51], s74 offen sc1
    s_add_u32 s74, s74, 0x20000
    v_add_u32 v99, 0x10000, v99
    v_perm_b32 v7, v99, v95, s76
    v_bfi_b32 v7, s53, v115, v7
    buffer_store_dwordx4 v[4:7], v117, s[48:51], s74 offen sc1
    ds_write_b32 v255, v254 offset:48
    s_cmp_eq_u32 s63, 1
    s_cbranch_scc1 L_fin
    s_add_u32 s60, s60, 16
    s_mov_b32 s77, 32768
    v_mov_b32 v32, v112
    v_mov_b32 v33, v113
    v_mov_b32 v34, v114
    v_mov_b32 v35, v115
    s_branch L_s3_entry

L_sidle:
    s_barrier
    s_load_dwordx2 s[20:21], s[0:1], 32
    s_load_dwordx2 s[24:25], s[0:1], 40
    s_load_dwordx2 s[28:29], s[0:1], 56
    s_load_dwordx2 s[32:33], s[0:1], 64
    s_load_dwordx2 s[36:37], s[0:1], 72
    s_load_dwordx2 s[40:41], s[0:1], 80
    s_load_dwordx2 s[44:45], s[0:1], 88
    s_mov_b32 s22, 0x400000
    s_mov_b32 s23, 0x20000
    s_mov_b32 s26, 0x400000
    s_mov_b32 s27, 0x20000
    s_mov_b32 s30, 0x1c0000
    s_mov_b32 s31, 0x20000
    s_mov_b32 s34, 0xe00
    s_mov_b32 s35, 0x20000
    s_mov_b32 s38, 0x1c0000
    s_mov_b32 s39, 0x20000
    s_mov_b32 s42, 0x400
    s_mov_b32 s43, 0x20000
    s_mov_b32 s46, 0x400
    s_mov_b32 s47, 0x20000
    s_mov_b32 s6, 0x400
    s_mov_b32 s7, 0x20000
    s_mov_b32 s50, 0x10000000
    s_mov_b32 s51, 0x20000
    s_lshr_b32 s70, s59, 1
    s_lshl_b32 s62, s58, 4
    s_add_u32 s62, s62, s70
    s_and_b32 s63, s59, 1
    s_cmp_eq_u32 s63, 1
    s_cselect_b32 s54, s70, 31
    s_mul_i32 s65, s58, 7
    s_add_u32 s65, s65, s54
    s_sub_u32 s55, s54, 7
    s_mov_b32 s76, 0x07060302

    s_lshl_b32 s67, s64, 2
    s_add_u32 s67, s67, 147968
    v_mov_b32 v255, s67
    v_mov_b32 v254, 1
    v_mov_b32 v253, 147968
    v_lshlrev_b32 v4, 4, v1
    s_getpc_b64 s[70:71]
L_pc:
    s_sub_u32 s70, s70, L_pc-sequential_preLN__compressed_kv_cla__dense_activation_gelu__decode_kernel
    s_subb_u32 s71, s71, 0
    s_and_b32 s72, s59, 15
    s_lshl_b32 s72, s72, 1
    s_add_u32 s72, s72, s64
    s_sub_u32 s72, s72, 2
    s_lshl_b32 s72, s72, 10
    v_add_u32 v5, s72, v4
    v_min_u32 v5, L_end-sequential_preLN__compressed_kv_cla__dense_activation_gelu__decode_kernel-16, v5
    v_and_b32 v5, 0xfffffff0, v5
    global_load_dwordx4 v[244:247], v5, s[70:71]

    s_waitcnt lgkmcnt(0)
    s_load_dword s57, s[48:49], 0
    s_lshl_b32 s71, s59, 1
    s_add_u32 s71, s71, s64
    s_sub_u32 s71, s71, 2
    s_bfe_u32 s70, s71, 0x10002
    s_lshl_b32 s70, s70, 15
    s_and_b32 s72, s71, 3
    s_lshl_b32 s72, s72, 10
    s_add_u32 s70, s70, s72
    s_lshl_b32 s72, s58, 12
    s_add_u32 s70, s70, s72
    s_add_u32 s70, s70, 2359296
    buffer_load_dwordx4 v[244:247], v4, s[48:51], s70 offen

    s_lshl_b32 s70, s58, 6
    s_add_u32 s70, s70, s71
    s_and_b32 s70, s70, 255
    s_lshl_b32 s72, s70, 10
    s_add_u32 s73, s72, 196608
    s_cmp_lt_u32 s70, 32
    s_cbranch_scc1 L_pt
    s_add_u32 s73, s72, 360448
    s_cmp_lt_u32 s70, 48
    s_cbranch_scc1 L_pt
    s_add_u32 s73, s72, 409600
    s_cmp_lt_u32 s70, 112
    s_cbranch_scc1 L_pt
    s_add_u32 s73, s72, 475136
    s_cmp_lt_u32 s70, 176
    s_cbranch_scc0 L_pt2
L_pt:
    buffer_load_dwordx4 v[244:247], v4, s[48:51], s73 offen sc1
L_pt2:

    s_waitcnt lgkmcnt(0)
    s_add_u32 s57, s57, 1
    s_and_b32 s56, s57, 0x3fff
    s_lshl_b32 s67, s57, 2
    s_and_b32 s67, s67, 0x3fff0000
    s_or_b32 s56, s56, s67
    s_and_b32 s52, s57, 0xff
    s_mul_i32 s67, s52, 0x01000100
    s_and_b32 s68, s57, 0xff00ff00
    s_add_u32 s67, s67, s68
    s_and_b32 s67, s67, 0xff00ff00
    s_or_b32 s69, s52, s67
    s_lshl_b32 s67, s52, 16
    s_add_u32 s67, s67, s57
    s_and_b32 s67, s67, 0x00ff0000
    s_or_b32 s52, s69, s67
    s_mov_b32 s53, 0x00010001
L_s_qg:
    v_lshlrev_b32 v4, 4, v1
    s_lshl_b32 s70, s63, 14
    s_lshl_b32 s71, s64, 12
    s_add_u32 s70, s70, s71
    s_add_u32 s70, s70, 196608
    v_lshlrev_b32 v7, 8, v3

    s_lshl_b32 s72, s64, 2
    s_add_u32 s72, s72, 0
    s_and_b32 s73, s72, 7
    s_lshl_b32 s73, s73, 1
    s_lshr_b32 s74, s72, 3
    s_or_b32 s73, s73, s74
    s_lshl_b32 s72, s72, 10
    s_add_u32 s72, s72, 131072
    v_xor_b32 v6, s73, v2
    v_lshl_add_u32 v6, v6, 4, v7
    v_add_u32 v8, s72, v6

    s_lshl_b32 s72, s64, 2
    s_add_u32 s72, s72, 1
    s_and_b32 s73, s72, 7
    s_lshl_b32 s73, s73, 1
    s_lshr_b32 s74, s72, 3
    s_or_b32 s73, s73, s74
    s_lshl_b32 s72, s72, 10
    s_add_u32 s72, s72, 131072
    v_xor_b32 v6, s73, v2
    v_lshl_add_u32 v6, v6, 4, v7
    v_add_u32 v9, s72, v6

    s_lshl_b32 s72, s64, 2
    s_add_u32 s72, s72, 2
    s_and_b32 s73, s72, 7
    s_lshl_b32 s73, s73, 1
    s_lshr_b32 s74, s72, 3
    s_or_b32 s73, s73, s74
    s_lshl_b32 s72, s72, 10
    s_add_u32 s72, s72, 131072
    v_xor_b32 v6, s73, v2
    v_lshl_add_u32 v6, v6, 4, v7
    v_add_u32 v10, s72, v6

    s_lshl_b32 s72, s64, 2
    s_add_u32 s72, s72, 3
    s_and_b32 s73, s72, 7
    s_lshl_b32 s73, s73, 1
    s_lshr_b32 s74, s72, 3
    s_or_b32 s73, s73, s74
    s_lshl_b32 s72, s72, 10
    s_add_u32 s72, s72, 131072
    v_xor_b32 v6, s73, v2
    v_lshl_add_u32 v6, v6, 4, v7
    v_add_u32 v11, s72, v6

    v_and_b32 v36, 3, v1
    v_lshlrev_b32 v36, 3, v36
    v_lshrrev_b32 v37, v36, s52
    v_bfe_u32 v32, v37, 0, 1
    v_bfe_u32 v36, v37, 1, 1
    v_lshl_or_b32 v32, v36, 16, v32
    v_bfe_u32 v33, v37, 2, 1
    v_bfe_u32 v36, v37, 3, 1
    v_lshl_or_b32 v33, v36, 16, v33
    v_bfe_u32 v34, v37, 4, 1
    v_bfe_u32 v36, v37, 5, 1
    v_lshl_or_b32 v34, v36, 16, v34
    v_bfe_u32 v35, v37, 6, 1
    v_bfe_u32 v36, v37, 7, 1
    v_lshl_or_b32 v35, v36, 16, v35
    s_mov_b32 s66, 0
fw_11:
    s_sleep 1
    ds_read_b32 v248, v253 offset:16
    s_add_u32 s66, s66, 1
    s_cmp_gt_u32 s66, 40000000
    s_cbranch_scc1 L_end
    s_waitcnt lgkmcnt(0)
    v_cmp_ne_u32 vcc, 1, v248
    s_cbranch_vccnz fw_11
    s_sleep 12
    buffer_load_dwordx4 v[64:67], v4, s[48:51], s70 offen offset:0 sc1
    buffer_load_dwordx4 v[68:71], v4, s[48:51], s70 offen offset:1024 sc1
    buffer_load_dwordx4 v[72:75], v4, s[48:51], s70 offen offset:2048 sc1
    buffer_load_dwordx4 v[76:79], v4, s[48:51], s70 offen offset:3072 sc1
    ds_write_b32 v255, v254 offset:176
    s_mov_b32 s66, 0
poll_12:
    s_waitcnt vmcnt(0)
    v_xor_b32 v250, v64, v32
    v_xor_b32 v251, v65, v33
    v_bitop3_b32 v250, v250, v66, v34 bitop3:0xf6
    v_bitop3_b32 v251, v251, v67, v35 bitop3:0xf6
    v_bitop3_b32 v250, v250, v68, v32 bitop3:0xf6
    v_bitop3_b32 v251, v251, v69, v33 bitop3:0xf6
    v_bitop3_b32 v250, v250, v70, v34 bitop3:0xf6
    v_bitop3_b32 v251, v251, v71, v35 bitop3:0xf6
    v_bitop3_b32 v250, v250, v72, v32 bitop3:0xf6
    v_bitop3_b32 v251, v251, v73, v33 bitop3:0xf6
    v_bitop3_b32 v250, v250, v74, v34 bitop3:0xf6
    v_bitop3_b32 v251, v251, v75, v35 bitop3:0xf6
    v_bitop3_b32 v250, v250, v76, v32 bitop3:0xf6
    v_bitop3_b32 v251, v251, v77, v33 bitop3:0xf6
    v_bitop3_b32 v250, v250, v78, v34 bitop3:0xf6
    v_bitop3_b32 v251, v251, v79, v35 bitop3:0xf6
    v_or_b32 v250, v250, v251
    v_and_b32 v248, s53, v250
    v_cmp_ne_u32 vcc, 0, v248
    s_cbranch_vccz pdone_13
    s_add_u32 s66, s66, 1
    s_cmp_gt_u32 s66, 2000000
    s_cbranch_scc1 L_end
    v_xor_b32 v251, v64, v32
    v_bitop3_b32 v251, v251, v65, v33 bitop3:0xf6
    v_bitop3_b32 v251, v251, v66, v34 bitop3:0xf6
    v_bitop3_b32 v251, v251, v67, v35 bitop3:0xf6
    v_and_b32 v251, s53, v251
    s_nop 1
    v_or_b32_dpp v251, v251, v251 quad_perm:[1,0,3,2] row_mask:0xf bank_mask:0xf
    s_nop 1
    v_or_b32_dpp v251, v251, v251 quad_perm:[2,3,0,1] row_mask:0xf bank_mask:0xf
    v_cmp_ne_u32 vcc, 0, v251
    s_cbranch_vccz ok_14
    s_mov_b64 exec, vcc
    buffer_load_dwordx4 v[64:67], v4, s[48:51], s70 offen offset:0 sc1
    s_mov_b64 exec, -1
ok_14:
    v_xor_b32 v251, v68, v32
    v_bitop3_b32 v251, v251, v69, v33 bitop3:0xf6
    v_bitop3_b32 v251, v251, v70, v34 bitop3:0xf6
    v_bitop3_b32 v251, v251, v71, v35 bitop3:0xf6
    v_and_b32 v251, s53, v251
    s_nop 1
    v_or_b32_dpp v251, v251, v251 quad_perm:[1,0,3,2] row_mask:0xf bank_mask:0xf
    s_nop 1
    v_or_b32_dpp v251, v251, v251 quad_perm:[2,3,0,1] row_mask:0xf bank_mask:0xf
    v_cmp_ne_u32 vcc, 0, v251
    s_cbranch_vccz ok_15
    s_mov_b64 exec, vcc
    buffer_load_dwordx4 v[68:71], v4, s[48:51], s70 offen offset:1024 sc1
    s_mov_b64 exec, -1
ok_15:
    v_xor_b32 v251, v72, v32
    v_bitop3_b32 v251, v251, v73, v33 bitop3:0xf6
    v_bitop3_b32 v251, v251, v74, v34 bitop3:0xf6
    v_bitop3_b32 v251, v251, v75, v35 bitop3:0xf6
    v_and_b32 v251, s53, v251
    s_nop 1
    v_or_b32_dpp v251, v251, v251 quad_perm:[1,0,3,2] row_mask:0xf bank_mask:0xf
    s_nop 1
    v_or_b32_dpp v251, v251, v251 quad_perm:[2,3,0,1] row_mask:0xf bank_mask:0xf
    v_cmp_ne_u32 vcc, 0, v251
    s_cbranch_vccz ok_16
    s_mov_b64 exec, vcc
    buffer_load_dwordx4 v[72:75], v4, s[48:51], s70 offen offset:2048 sc1
    s_mov_b64 exec, -1
ok_16:
    v_xor_b32 v251, v76, v32
    v_bitop3_b32 v251, v251, v77, v33 bitop3:0xf6
    v_bitop3_b32 v251, v251, v78, v34 bitop3:0xf6
    v_bitop3_b32 v251, v251, v79, v35 bitop3:0xf6
    v_and_b32 v251, s53, v251
    s_nop 1
    v_or_b32_dpp v251, v251, v251 quad_perm:[1,0,3,2] row_mask:0xf bank_mask:0xf
    s_nop 1
    v_or_b32_dpp v251, v251, v251 quad_perm:[2,3,0,1] row_mask:0xf bank_mask:0xf
    v_cmp_ne_u32 vcc, 0, v251
    s_cbranch_vccz ok_17
    s_mov_b64 exec, vcc
    buffer_load_dwordx4 v[76:79], v4, s[48:51], s70 offen offset:3072 sc1
    s_mov_b64 exec, -1
ok_17:
    s_branch poll_12
pdone_13:
    v_xor_b32 v64, v64, v32
    v_xor_b32 v65, v65, v33
    v_xor_b32 v66, v66, v34
    v_xor_b32 v67, v67, v35
    ds_write_b128 v8, v[64:67]
    v_xor_b32 v68, v68, v32
    v_xor_b32 v69, v69, v33
    v_xor_b32 v70, v70, v34
    v_xor_b32 v71, v71, v35
    ds_write_b128 v9, v[68:71]
    v_xor_b32 v72, v72, v32
    v_xor_b32 v73, v73, v33
    v_xor_b32 v74, v74, v34
    v_xor_b32 v75, v75, v35
    ds_write_b128 v10, v[72:75]
    v_xor_b32 v76, v76, v32
    v_xor_b32 v77, v77, v33
    v_xor_b32 v78, v78, v34
    v_xor_b32 v79, v79, v35
    ds_write_b128 v11, v[76:79]
    ds_write_b32 v255, v254 offset:32
    s_setprio 0
    s_cmp_eq_u32 s63, 1
    s_cbranch_scc1 L_odd
    s_mov_b32 s66, 0
fw_18:
    s_sleep 1
    ds_read_b128 v[248:251], v253 offset:192
    s_add_u32 s66, s66, 1
    s_cmp_gt_u32 s66, 40000000
    s_cbranch_scc1 L_end
    s_waitcnt lgkmcnt(0)
    v_and_b32 v248, v248, v249
    v_bitop3_b32 v248, v248, v250, v251 bitop3:0x80
    v_cmp_ne_u32 vcc, 1, v248
    s_cbranch_vccnz fw_18
    v_lshlrev_b32 v6, 17, v3
    v_lshl_add_u32 v6, v2, 4, v6
    s_lshr_b32 s70, s61, 1
    s_lshl_b32 s70, s70, 20
    s_and_b32 s71, s61, 1
    s_lshl_b32 s71, s71, 16
    s_add_u32 s70, s70, s71
    s_lshl_b32 s71, s60, 8
    s_add_u32 s70, s70, s71
    s_lshl_b32 s71, s64, 14
    s_add_u32 s70, s70, s71

    s_add_u32 s72, s70, 0
    buffer_load_dwordx4 v[96:99], v6, s[20:23], s72 offen nt
    s_add_u32 s72, s70, 524288
    buffer_load_dwordx4 v[100:103], v6, s[20:23], s72 offen nt
    s_add_u32 s72, s70, 8192
    buffer_load_dwordx4 v[104:107], v6, s[20:23], s72 offen nt
    s_add_u32 s72, s70, 532480
    buffer_load_dwordx4 v[108:111], v6, s[20:23], s72 offen nt
    s_add_u32 s72, s70, 4096
    buffer_load_dwordx4 v[112:115], v6, s[20:23], s72 offen nt
    s_add_u32 s72, s70, 528384
    buffer_load_dwordx4 v[116:119], v6, s[20:23], s72 offen nt
    s_add_u32 s72, s70, 12288
    buffer_load_dwordx4 v[120:123], v6, s[20:23], s72 offen nt
    s_add_u32 s72, s70, 536576
    buffer_load_dwordx4 v[124:127], v6, s[20:23], s72 offen nt
    s_mov_b32 s77, 0
L_s3_entry:
    v_mov_b32 v36, 0x302
    v_or_b32 v37, 0x0c0c0000, v36
    v_lshlrev_b32 v36, 16, v36
    v_or_b32 v36, 0x0c0c, v36
    v_and_b32 v38, 1, v2
    v_cmp_eq_u32 vcc, 0, v38
    s_nop 1
    v_cndmask_b32 v36, v36, v37, vcc
    v_bfe_u32 v38, v2, 1, 2
    v_mov_b32 v37, 0x0c0c0c0c

    v_cmp_eq_u32 vcc, 0, v38
    s_nop 1
    v_cndmask_b32 v24, v37, v36, vcc
    v_cmp_eq_u32 vcc, 1, v38
    s_nop 1
    v_cndmask_b32 v25, v37, v36, vcc
    v_cmp_eq_u32 vcc, 2, v38
    s_nop 1
    v_cndmask_b32 v26, v37, v36, vcc
    v_cmp_eq_u32 vcc, 3, v38
    s_nop 1
    v_cndmask_b32 v27, v37, v36, vcc
    v_lshlrev_b32 v10, 4, v1
    s_lshl_b32 s74, s60, 3
    s_add_u32 s74, s74, s61
    s_lshl_b32 s73, s74, 8
    s_lshl_b32 s74, s74, 14
    s_lshl_b32 s71, s64, 12
    s_add_u32 s74, s74, s71
    s_add_u32 s74, s74, 16777216
    s_lshl_b32 s71, s64, 6
    s_add_u32 s73, s73, s71
    s_add_u32 s73, s73, 262144
    s_lshr_b32 s75, s60, 4
    s_lshl_b32 s75, s75, 15
    s_lshl_b32 s71, s64, 13
    s_add_u32 s75, s75, s71
    s_and_b32 s71, s60, 15
    s_lshl_b32 s71, s71, 4
    s_add_u32 s75, s75, s71
    s_add_u32 s75, s75, 589824
    v_lshrrev_b32 v11, 3, v1
    v_lshlrev_b32 v11, 8, v11
    v_add_u32 v13, 4096, v11
    v_and_b32 v36, 1, v3
    v_lshlrev_b32 v7, 3, v36
    v_lshl_add_u32 v7, v2, 4, v7
    s_lshl_b32 s72, s64, 8
    s_add_u32 s72, s72, 16384
    s_add_u32 s72, s72, s77
    v_add_u32 v12, s72, v7
    s_lshl_b32 s72, s64, 3
    s_add_u32 s72, s72, 17408
    s_add_u32 s72, s72, s77
    v_mov_b32 v14, s72
    v_and_b32 v6, 7, v2
    v_lshlrev_b32 v15, 7, v6
    v_lshl_add_u32 v15, v3, 4, v15
    v_add_u32 v15, s77, v15
    s_add_u32 s72, s77, 17408
    v_mov_b32 v16, s72
    v_lshlrev_b32 v17, 4, v36
    v_add_u32 v17, s77, v17
    v_lshlrev_b32 v18, 2, v2
    s_lshl_b32 s70, s64, 12
    v_lshlrev_b32 v4, 4, v1
    v_add_u32 v4, s70, v4
    v_bfe_u32 v5, v1, 2, 2
    v_and_b32 v6, 3, v1
    v_lshlrev_b32 v6, 3, v6
    v_lshl_add_u32 v7, v3, 3, v5
    v_lshl_add_u32 v8, v7, 8, v6
    s_lshl_b32 s71, s64, 6
    s_add_u32 s71, s71, s77
    v_add_u32 v8, s71, v8

    v_lshlrev_b32 v36, 1, v2
    v_lshrrev_b32 v36, v36, s52
    v_bfe_u32 v19, v36, 1, 1
    v_and_b32 v36, 1, v36
    v_lshl_or_b32 v19, v19, 16, v36

    s_mov_b32 s66, 0
fw_19:
    s_sleep 1
    ds_read_b128 v[248:251], v253 offset:48
    s_add_u32 s66, s66, 1
    s_cmp_gt_u32 s66, 40000000
    s_cbranch_scc1 L_end
    s_waitcnt lgkmcnt(0)
    v_and_b32 v248, v248, v249
    v_bitop3_b32 v248, v248, v250, v251 bitop3:0x80
    v_cmp_ne_u32 vcc, 1, v248
    s_cbranch_vccnz fw_19
    s_setprio 3
    s_cmp_lg_u32 s77, 0
    s_cbranch_scc1 L_t1a
    s_waitcnt vmcnt(0)
    ds_write_b128 v4, v[96:99] offset:0
    ds_write_b128 v4, v[100:103] offset:1024
    ds_write_b128 v4, v[104:107] offset:2048
    ds_write_b128 v4, v[108:111] offset:3072
    ds_write_b128 v4, v[112:115] offset:32768
    ds_write_b128 v4, v[116:119] offset:33792
    ds_write_b128 v4, v[120:123] offset:34816
    ds_write_b128 v4, v[124:127] offset:35840
    ds_write_b32 v255, v254 offset:64
    s_sleep 22
    s_branch L_t1b
L_t1a:
    s_sleep 14
L_t1b:
    buffer_load_dwordx4 v[208:211], v11, s[48:51], s75 offen offset:0 sc1
    buffer_load_dwordx4 v[212:215], v11, s[48:51], s75 offen offset:2048 sc1
    buffer_load_dwordx4 v[216:219], v13, s[48:51], s75 offen offset:0 sc1
    buffer_load_dwordx4 v[220:223], v13, s[48:51], s75 offen offset:2048 sc1
    buffer_load_dwordx4 v[192:195], v10, s[48:51], s74 offen offset:0 sc1
    buffer_load_dwordx4 v[196:199], v10, s[48:51], s74 offen offset:1024 sc1
    buffer_load_dwordx4 v[200:203], v10, s[48:51], s74 offen offset:2048 sc1
    buffer_load_dwordx4 v[204:207], v10, s[48:51], s74 offen offset:3072 sc1
    s_mov_b32 s66, 0
fw_20:
    s_waitcnt lgkmcnt(2)
    ds_read_b128 v[248:251], v253 offset:64
    ds_read_b64_tr_b16 v[64:65], v8 offset:0
    ds_read_b64_tr_b16 v[66:67], v8 offset:1024
    ds_read_b64_tr_b16 v[68:69], v8 offset:8192
    ds_read_b64_tr_b16 v[70:71], v8 offset:9216
    ds_read_b64_tr_b16 v[72:73], v8 offset:32
    ds_read_b64_tr_b16 v[74:75], v8 offset:1056
    ds_read_b64_tr_b16 v[76:77], v8 offset:8224
    ds_read_b64_tr_b16 v[78:79], v8 offset:9248
    s_add_u32 s66, s66, 1
    s_cmp_gt_u32 s66, 40000000
    s_cbranch_scc1 L_end
    s_waitcnt lgkmcnt(8)
    v_and_b32 v248, v248, v249
    v_bitop3_b32 v248, v248, v250, v251 bitop3:0x80
    v_cmp_ne_u32 vcc, 1, v248
    s_cbranch_vccnz fw_20
    s_lshr_b32 s70, s77, 7
    v_add_u32 v253, s70, v253
    v_add_u32 v255, s70, v255
    s_mov_b32 s66, 0
poll_21:
    s_waitcnt vmcnt(0)
    v_xor_b32 v248, s56, v211
    v_bitop3_b32 v248, v248, v215, s56 bitop3:0xf6
    v_bitop3_b32 v248, v248, v219, s56 bitop3:0xf6
    v_bitop3_b32 v248, v248, v223, s56 bitop3:0xf6
    v_xor_b32 v250, v192, v32
    v_xor_b32 v251, v193, v33
    v_bitop3_b32 v250, v250, v194, v34 bitop3:0xf6
    v_bitop3_b32 v251, v251, v195, v35 bitop3:0xf6
    v_bitop3_b32 v250, v250, v196, v32 bitop3:0xf6
    v_bitop3_b32 v251, v251, v197, v33 bitop3:0xf6
    v_bitop3_b32 v250, v250, v198, v34 bitop3:0xf6
    v_bitop3_b32 v251, v251, v199, v35 bitop3:0xf6
    v_bitop3_b32 v250, v250, v200, v32 bitop3:0xf6
    v_bitop3_b32 v251, v251, v201, v33 bitop3:0xf6
    v_bitop3_b32 v250, v250, v202, v34 bitop3:0xf6
    v_bitop3_b32 v251, v251, v203, v35 bitop3:0xf6
    v_bitop3_b32 v250, v250, v204, v32 bitop3:0xf6
    v_bitop3_b32 v251, v251, v205, v33 bitop3:0xf6
    v_bitop3_b32 v250, v250, v206, v34 bitop3:0xf6
    v_bitop3_b32 v251, v251, v207, v35 bitop3:0xf6
    v_or_b32 v250, v250, v251
    v_and_or_b32 v248, v250, s53, v248
    v_cmp_ne_u32 vcc, 0, v248
    s_cbranch_vccz pdone_22
    s_add_u32 s66, s66, 1
    s_cmp_gt_u32 s66, 2000000
    s_cbranch_scc1 L_end
    v_cmp_ne_u32 vcc, s56, v211
    s_cbranch_vccz ok_23
    s_mov_b64 exec, vcc
    buffer_load_dwordx4 v[208:211], v11, s[48:51], s75 offen offset:0 sc1
    s_mov_b64 exec, -1
ok_23:
    v_cmp_ne_u32 vcc, s56, v215
    s_cbranch_vccz ok_24
    s_mov_b64 exec, vcc
    buffer_load_dwordx4 v[212:215], v11, s[48:51], s75 offen offset:2048 sc1
    s_mov_b64 exec, -1
ok_24:
    v_cmp_ne_u32 vcc, s56, v219
    s_cbranch_vccz ok_25
    s_mov_b64 exec, vcc
    buffer_load_dwordx4 v[216:219], v13, s[48:51], s75 offen offset:0 sc1
    s_mov_b64 exec, -1
ok_25:
    v_cmp_ne_u32 vcc, s56, v223
    s_cbranch_vccz ok_26
    s_mov_b64 exec, vcc
    buffer_load_dwordx4 v[220:223], v13, s[48:51], s75 offen offset:2048 sc1
    s_mov_b64 exec, -1
ok_26:
    v_xor_b32 v251, v192, v32
    v_bitop3_b32 v251, v251, v193, v33 bitop3:0xf6
    v_bitop3_b32 v251, v251, v194, v34 bitop3:0xf6
    v_bitop3_b32 v251, v251, v195, v35 bitop3:0xf6
    v_and_b32 v251, s53, v251
    s_nop 1
    v_or_b32_dpp v251, v251, v251 quad_perm:[1,0,3,2] row_mask:0xf bank_mask:0xf
    s_nop 1
    v_or_b32_dpp v251, v251, v251 quad_perm:[2,3,0,1] row_mask:0xf bank_mask:0xf
    v_cmp_ne_u32 vcc, 0, v251
    s_cbranch_vccz ok_27
    s_mov_b64 exec, vcc
    buffer_load_dwordx4 v[192:195], v10, s[48:51], s74 offen offset:0 sc1
    s_mov_b64 exec, -1
ok_27:
    v_xor_b32 v251, v196, v32
    v_bitop3_b32 v251, v251, v197, v33 bitop3:0xf6
    v_bitop3_b32 v251, v251, v198, v34 bitop3:0xf6
    v_bitop3_b32 v251, v251, v199, v35 bitop3:0xf6
    v_and_b32 v251, s53, v251
    s_nop 1
    v_or_b32_dpp v251, v251, v251 quad_perm:[1,0,3,2] row_mask:0xf bank_mask:0xf
    s_nop 1
    v_or_b32_dpp v251, v251, v251 quad_perm:[2,3,0,1] row_mask:0xf bank_mask:0xf
    v_cmp_ne_u32 vcc, 0, v251
    s_cbranch_vccz ok_28
    s_mov_b64 exec, vcc
    buffer_load_dwordx4 v[196:199], v10, s[48:51], s74 offen offset:1024 sc1
    s_mov_b64 exec, -1
ok_28:
    v_xor_b32 v251, v200, v32
    v_bitop3_b32 v251, v251, v201, v33 bitop3:0xf6
    v_bitop3_b32 v251, v251, v202, v34 bitop3:0xf6
    v_bitop3_b32 v251, v251, v203, v35 bitop3:0xf6
    v_and_b32 v251, s53, v251
    s_nop 1
    v_or_b32_dpp v251, v251, v251 quad_perm:[1,0,3,2] row_mask:0xf bank_mask:0xf
    s_nop 1
    v_or_b32_dpp v251, v251, v251 quad_perm:[2,3,0,1] row_mask:0xf bank_mask:0xf
    v_cmp_ne_u32 vcc, 0, v251
    s_cbranch_vccz ok_29
    s_mov_b64 exec, vcc
    buffer_load_dwordx4 v[200:203], v10, s[48:51], s74 offen offset:2048 sc1
    s_mov_b64 exec, -1
ok_29:
    v_xor_b32 v251, v204, v32
    v_bitop3_b32 v251, v251, v205, v33 bitop3:0xf6
    v_bitop3_b32 v251, v251, v206, v34 bitop3:0xf6
    v_bitop3_b32 v251, v251, v207, v35 bitop3:0xf6
    v_and_b32 v251, s53, v251
    s_nop 1
    v_or_b32_dpp v251, v251, v251 quad_perm:[1,0,3,2] row_mask:0xf bank_mask:0xf
    s_nop 1
    v_or_b32_dpp v251, v251, v251 quad_perm:[2,3,0,1] row_mask:0xf bank_mask:0xf
    v_cmp_ne_u32 vcc, 0, v251
    s_cbranch_vccz ok_30
    s_mov_b64 exec, vcc
    buffer_load_dwordx4 v[204:207], v10, s[48:51], s74 offen offset:3072 sc1
    s_mov_b64 exec, -1
ok_30:
    s_branch poll_21
pdone_22:
    v_max3_f32 v36, v208, v212, v216
    v_max_f32 v36, v36, v220
    v_xor_b32 v192, v192, v32
    v_xor_b32 v193, v193, v33
    v_xor_b32 v194, v194, v34
    v_xor_b32 v195, v195, v35
    v_max_f32_dpp v36, v36, v36 row_ror:8 row_mask:0xf bank_mask:0xf
    v_mov_b32 v37, v36
    v_xor_b32 v196, v196, v32
    v_xor_b32 v197, v197, v33
    v_xor_b32 v198, v198, v34
    v_xor_b32 v199, v199, v35
    v_permlane16_swap_b32 v36, v37
    v_max_f32 v36, v36, v37
    v_mov_b32 v37, v36
    v_xor_b32 v200, v200, v32
    v_xor_b32 v201, v201, v33
    v_xor_b32 v202, v202, v34
    v_xor_b32 v203, v203, v35
    v_permlane32_swap_b32 v36, v37
    v_max_f32 v36, v36, v37
    v_xor_b32 v204, v204, v32
    v_xor_b32 v205, v205, v33
    v_xor_b32 v206, v206, v34
    v_xor_b32 v207, v207, v35
    v_sub_f32 v40, v208, v36
    v_sub_f32 v41, v212, v36
    v_sub_f32 v42, v216, v36
    v_sub_f32 v43, v220, v36
    v_cvt_i32_f32 v40, v40
    v_cvt_i32_f32 v41, v41
    v_cvt_i32_f32 v42, v42
    v_cvt_i32_f32 v43, v43
    v_ldexp_f32 v40, 1.0, v40
    v_ldexp_f32 v41, 1.0, v41
    v_ldexp_f32 v42, 1.0, v42
    v_ldexp_f32 v43, 1.0, v43
    v_perm_b32 v160, v40, v40, v24
    v_perm_b32 v161, v40, v40, v25
    v_perm_b32 v162, v40, v40, v26
    v_perm_b32 v163, v40, v40, v27
    v_perm_b32 v164, v41, v41, v24
    v_perm_b32 v165, v41, v41, v25
    v_perm_b32 v166, v41, v41, v26
    v_perm_b32 v167, v41, v41, v27
    v_mfma_f32_16x16x32_bf16 v[48:51], v[160:163], v[192:195], 0
    v_perm_b32 v168, v42, v42, v24
    v_perm_b32 v169, v42, v42, v25
    v_perm_b32 v170, v42, v42, v26
    v_perm_b32 v171, v42, v42, v27
    v_mfma_f32_16x16x32_bf16 v[48:51], v[164:167], v[196:199], v[48:51]
    v_perm_b32 v172, v43, v43, v24
    v_perm_b32 v173, v43, v43, v25
    v_perm_b32 v174, v43, v43, v26
    v_perm_b32 v175, v43, v43, v27
    v_mfma_f32_16x16x32_bf16 v[48:51], v[168:171], v[200:203], v[48:51]
    s_nop 0
    v_mfma_f32_16x16x32_bf16 v[48:51], v[172:175], v[204:207], v[48:51]
    v_mul_f32 v37, v40, v209
    v_fmac_f32 v37, v41, v213
    v_fmac_f32 v37, v42, v217
    v_fmac_f32 v37, v43, v221
    s_nop 1
    v_add_f32_dpp v37, v37, v37 row_ror:8 row_mask:0xf bank_mask:0xf
    v_mov_b32 v38, v37
    s_nop 1
    v_permlane16_swap_b32 v37, v38
    v_add_f32 v37, v37, v38
    v_mov_b32 v38, v37
    s_nop 1
    v_permlane32_swap_b32 v37, v38
    v_add_f32 v37, v37, v38
    v_cvt_pk_bf16_f32 v52, v48, v49
    v_cvt_pk_bf16_f32 v53, v50, v51
    s_mov_b32 exec_lo, 0x00ff00ff
    s_mov_b32 exec_hi, 0xff00ff00
    ds_write_b64 v12, v[52:53]
    s_mov_b64 exec, 1
    ds_write_b64 v14, v[36:37]
    s_mov_b64 exec, -1
    ds_write_b32 v255, v254 offset:80
    s_mov_b32 s66, 0
fw_31:
    ds_read_b128 v[248:251], v253 offset:80
    ds_read_b128 v[40:43], v15 offset:16384
    ds_read_b128 v[44:47], v15 offset:16448
    ds_read_b128 v[48:51], v16
    ds_read_b128 v[52:55], v16 offset:16
    ds_read_b128 v[56:59], v17 offset:17408
    s_add_u32 s66, s66, 1
    s_cmp_gt_u32 s66, 40000000
    s_cbranch_scc1 L_end
    s_waitcnt lgkmcnt(5)
    v_and_b32 v248, v248, v249
    v_bitop3_b32 v248, v248, v250, v251 bitop3:0x80
    v_cmp_ne_u32 vcc, 1, v248
    s_cbranch_vccnz fw_31
    s_waitcnt lgkmcnt(3)
    v_mfma_f32_16x16x32_bf16 v[160:163], v[40:43], v[64:67], 0
    v_mfma_f32_16x16x32_bf16 v[160:163], v[44:47], v[68:71], v[160:163]
    v_mfma_f32_16x16x32_bf16 v[164:167], v[40:43], v[72:75], 0
    v_mfma_f32_16x16x32_bf16 v[164:167], v[44:47], v[76:79], v[164:167]
    s_waitcnt lgkmcnt(0)
    v_max3_f32 v36, v48, v50, v52
    v_max_f32 v36, v36, v54
    v_sub_f32 v48, v48, v36
    v_sub_f32 v50, v50, v36
    v_sub_f32 v52, v52, v36
    v_sub_f32 v54, v54, v36
    v_sub_f32 v56, v56, v36
    v_sub_f32 v58, v58, v36
    v_exp_f32 v48, v48
    v_exp_f32 v50, v50
    v_exp_f32 v52, v52
    v_exp_f32 v54, v54
    v_exp_f32 v56, v56
    v_exp_f32 v58, v58
    v_mul_f32 v37, v48, v49
    v_fmac_f32 v37, v50, v51
    v_fmac_f32 v37, v52, v53
    v_fmac_f32 v37, v54, v55
    v_rcp_f32 v37, v37
    v_add_f32 v160, v160, v161
    v_add_f32 v162, v162, v163
    v_add_f32 v164, v164, v165
    v_add_f32 v166, v166, v167
    v_mul_f32 v56, v56, v37
    v_mul_f32 v58, v58, v37
    v_mul_f32 v40, v160, v56
    v_mul_f32 v41, v164, v56
    v_fmac_f32 v40, v162, v58
    v_fmac_f32 v41, v166, v58

    v_mov_b32 v42, v40
    v_mov_b32 v43, v41
    s_nop 0
    v_permlane16_swap_b32 v40, v42
    v_permlane16_swap_b32 v41, v43
    v_add_f32 v40, v40, v42
    v_add_f32 v41, v41, v43
    v_add_u32 v40, 0x10000, v40
    v_add_u32 v41, 0x10000, v41
    v_perm_b32 v44, v41, v40, s76
    v_bfi_b32 v44, s53, v19, v44
    s_add_u32 s68, s73, 2097152
    s_mov_b64 exec, 0xffff
    buffer_store_dword v44, v18, s[48:51], s68 offen offset:0
    buffer_store_dword v44, v18, s[48:51], s73 offen offset:0 sc1
    s_mov_b64 exec, -1
    s_branch L_fin
L_odd:
    s_cmp_lt_u32 s54, 7
    s_cbranch_scc1 L_mlp
    s_cmp_ge_u32 s55, 8
    s_cbranch_scc1 L_fin
    v_lshlrev_b32 v10, 4, v1
    v_lshlrev_b32 v18, 2, v2
    v_bfe_u32 v5, v1, 2, 2
    v_and_b32 v6, 3, v1
    v_lshlrev_b32 v6, 3, v6
    v_lshl_add_u32 v7, v3, 3, v5
    s_lshl_b32 s71, s64, 6
    v_add_u32 v6, s71, v6
    v_and_b32 v36, 1, v3
    v_lshl_add_u32 v36, v36, 2, v5
    v_lshlrev_b32 v36, 5, v36
    v_xor_b32 v6, v6, v36
    v_lshl_add_u32 v9, v7, 8, v6
    v_add_u32 v9, 32768, v9
    v_xor_b32 v23, 32, v9
    v_add_u32 v22, 0x8000, v9
    v_add_u32 v17, 0x8000, v23
    s_lshl_b32 s72, s64, 9
    s_add_u32 s72, s72, 24576
    v_lshrrev_b32 v36, 1, v3
    v_lshlrev_b32 v20, 8, v36
    v_and_b32 v36, 1, v3
    v_lshl_add_u32 v20, v36, 3, v20
    v_lshl_add_u32 v20, v2, 4, v20
    v_add_u32 v20, s72, v20
    v_lshlrev_b32 v21, 4, v3
    v_add_u32 v21, s72, v21
    s_lshr_b32 s71, s55, 2
    s_lshl_b32 s74, s71, 4
    s_lshl_b32 s72, s58, 1
    s_add_u32 s74, s74, s72
    s_lshl_b32 s74, s74, 11
    s_add_u32 s74, s74, 262144
    s_add_u32 s73, s72, s71
    s_lshl_b32 s73, s73, 10
    s_and_b32 s71, s55, 3
    s_lshl_b32 s71, s71, 8
    s_add_u32 s73, s73, s71
    s_lshl_b32 s71, s64, 6
    s_add_u32 s73, s73, s71
    s_add_u32 s73, s73, 393216

    v_lshlrev_b32 v36, 1, v2
    v_lshrrev_b32 v36, v36, s52
    v_bfe_u32 v19, v36, 1, 1
    v_and_b32 v36, 1, v36
    v_lshl_or_b32 v19, v19, 16, v36

    v_and_b32 v36, 1, v2
    v_lshlrev_b32 v36, 4, v36
    v_mov_b32 v37, 0x3f80
    v_lshlrev_b32 v36, v36, v37
    v_lshrrev_b32 v37, 1, v2

    v_cmp_eq_u32 vcc, 0, v37
    s_nop 1
    v_cndmask_b32 v224, 0, v36, vcc
    v_cmp_eq_u32 vcc, 1, v37
    s_nop 1
    v_cndmask_b32 v225, 0, v36, vcc
    v_cmp_eq_u32 vcc, 2, v37
    s_nop 1
    v_cndmask_b32 v226, 0, v36, vcc
    v_cmp_eq_u32 vcc, 3, v37
    s_nop 1
    v_cndmask_b32 v227, 0, v36, vcc
    v_and_b32 v36, 1, v2
    v_lshlrev_b32 v36, 4, v36
    v_mov_b32 v37, 0x3f80
    v_lshlrev_b32 v36, v36, v37
    v_lshrrev_b32 v37, 1, v2

    v_cmp_eq_u32 vcc, 4, v37
    s_nop 1
    v_cndmask_b32 v228, 0, v36, vcc
    v_cmp_eq_u32 vcc, 5, v37
    s_nop 1
    v_cndmask_b32 v229, 0, v36, vcc
    v_cmp_eq_u32 vcc, 6, v37
    s_nop 1
    v_cndmask_b32 v230, 0, v36, vcc
    v_cmp_eq_u32 vcc, 7, v37
    s_nop 1
    v_cndmask_b32 v231, 0, v36, vcc
    v_and_b32 v36, 3, v1
    v_lshlrev_b32 v36, 3, v36
    v_lshrrev_b32 v37, v36, s52
    v_bfe_u32 v240, v37, 0, 1
    v_bfe_u32 v36, v37, 1, 1
    v_lshl_or_b32 v240, v36, 16, v240
    v_bfe_u32 v241, v37, 2, 1
    v_bfe_u32 v36, v37, 3, 1
    v_lshl_or_b32 v241, v36, 16, v241
    v_bfe_u32 v242, v37, 4, 1
    v_bfe_u32 v36, v37, 5, 1
    v_lshl_or_b32 v242, v36, 16, v242
    v_bfe_u32 v243, v37, 6, 1
    v_bfe_u32 v36, v37, 7, 1
    v_lshl_or_b32 v243, v36, 16, v243
    s_mov_b32 s66, 0
fw_32:
    s_sleep 1
    ds_read_b128 v[248:251], v253 offset:32
    s_add_u32 s66, s66, 1
    s_cmp_gt_u32 s66, 40000000
    s_cbranch_scc1 L_end
    s_waitcnt lgkmcnt(0)
    v_and_b32 v248, v248, v249
    v_bitop3_b32 v248, v248, v250, v251 bitop3:0x80
    v_cmp_ne_u32 vcc, 1, v248
    s_cbranch_vccnz fw_32
    s_mov_b32 s66, 0
fw_33:
    s_sleep 1
    ds_read_b128 v[248:251], v253 offset:192
    s_add_u32 s66, s66, 1
    s_cmp_gt_u32 s66, 40000000
    s_cbranch_scc1 L_end
    s_waitcnt lgkmcnt(0)
    v_and_b32 v248, v248, v249
    v_bitop3_b32 v248, v248, v250, v251 bitop3:0x80
    v_cmp_ne_u32 vcc, 1, v248
    s_cbranch_vccnz fw_33
    v_lshrrev_b32 v6, 1, v3
    v_and_b32 v7, 1, v3
    v_lshl_add_u32 v6, v7, 4, v6
    v_lshlrev_b32 v6, 10, v6
    v_lshlrev_b32 v7, 1, v3
    v_xor_b32 v7, v7, v2
    v_lshl_add_u32 v6, v7, 4, v6
    v_xor_b32 v7, 0x80, v6
    s_lshr_b32 s70, s55, 2
    s_lshl_b32 s70, s70, 4
    s_lshl_b32 s71, s58, 1
    s_add_u32 s70, s70, s71
    s_lshl_b32 s70, s70, 17
    s_lshl_b32 s71, s64, 16
    s_add_u32 s70, s70, s71
    s_and_b32 s71, s55, 3
    s_lshl_b32 s71, s71, 8
    s_add_u32 s70, s70, s71

    s_add_u32 s72, s70, 0
    buffer_load_dwordx4 v[64:67], v6, s[24:27], s72 offen nt
    s_add_u32 s72, s70, 2048
    buffer_load_dwordx4 v[68:71], v6, s[24:27], s72 offen nt
    s_add_u32 s72, s70, 4096
    buffer_load_dwordx4 v[72:75], v7, s[24:27], s72 offen nt
    s_add_u32 s72, s70, 6144
    buffer_load_dwordx4 v[76:79], v7, s[24:27], s72 offen nt
    s_mov_b32 s66, 0
fw_34:
    s_sleep 1
    ds_read_b128 v[248:251], v253 offset:48
    s_add_u32 s66, s66, 1
    s_cmp_gt_u32 s66, 40000000
    s_cbranch_scc1 L_end
    s_waitcnt lgkmcnt(0)
    v_and_b32 v248, v248, v249
    v_bitop3_b32 v248, v248, v250, v251 bitop3:0x80
    v_cmp_ne_u32 vcc, 1, v248
    s_cbranch_vccnz fw_34
    v_lshrrev_b32 v6, 1, v3
    v_and_b32 v7, 1, v3
    v_lshl_add_u32 v6, v7, 4, v6
    v_lshlrev_b32 v6, 10, v6
    v_lshlrev_b32 v7, 1, v3
    v_xor_b32 v7, v7, v2
    v_lshl_add_u32 v6, v7, 4, v6
    v_xor_b32 v7, 0x80, v6
    s_lshr_b32 s70, s55, 2
    s_lshl_b32 s70, s70, 4
    s_lshl_b32 s71, s58, 1
    s_add_u32 s70, s70, s71
    s_lshl_b32 s70, s70, 17
    s_lshl_b32 s71, s64, 16
    s_add_u32 s70, s70, s71
    s_and_b32 s71, s55, 3
    s_lshl_b32 s71, s71, 8
    s_add_u32 s70, s70, s71

    s_lshl_b32 s69, s64, 14
    s_add_u32 s69, s69, 32768
    s_add_u32 s72, s70, 8192
    s_add_u32 m0, s69, 4096
    s_nop 0
    buffer_load_dwordx4 v6, s[24:27], s72 offen nt lds
    s_add_u32 s72, s70, 10240
    s_add_u32 m0, s69, 5120
    s_nop 0
    buffer_load_dwordx4 v6, s[24:27], s72 offen nt lds
    s_add_u32 s72, s70, 12288
    s_add_u32 m0, s69, 6144
    s_nop 0
    buffer_load_dwordx4 v7, s[24:27], s72 offen nt lds
    s_add_u32 s72, s70, 14336
    s_add_u32 m0, s69, 7168
    s_nop 0
    buffer_load_dwordx4 v7, s[24:27], s72 offen nt lds
    s_add_u32 s72, s70, 32768
    s_add_u32 m0, s69, 8192
    s_nop 0
    buffer_load_dwordx4 v6, s[24:27], s72 offen nt lds
    s_add_u32 s72, s70, 34816
    s_add_u32 m0, s69, 9216
    s_nop 0
    buffer_load_dwordx4 v6, s[24:27], s72 offen nt lds
    s_add_u32 s72, s70, 36864
    s_add_u32 m0, s69, 10240
    s_nop 0
    buffer_load_dwordx4 v7, s[24:27], s72 offen nt lds
    s_add_u32 s72, s70, 38912
    s_add_u32 m0, s69, 11264
    s_nop 0
    buffer_load_dwordx4 v7, s[24:27], s72 offen nt lds
    s_add_u32 s72, s70, 40960
    s_add_u32 m0, s69, 12288
    s_nop 0
    buffer_load_dwordx4 v6, s[24:27], s72 offen nt lds
    s_add_u32 s72, s70, 43008
    s_add_u32 m0, s69, 13312
    s_nop 0
    buffer_load_dwordx4 v6, s[24:27], s72 offen nt lds
    s_add_u32 s72, s70, 45056
    s_add_u32 m0, s69, 14336
    s_nop 0
    buffer_load_dwordx4 v7, s[24:27], s72 offen nt lds
    s_add_u32 s72, s70, 47104
    s_add_u32 m0, s69, 15360
    s_nop 0
    buffer_load_dwordx4 v7, s[24:27], s72 offen nt lds
    v_add_u32 v5, s69, v10
    s_waitcnt vmcnt(12)
    ds_write_b128 v5, v[64:67] offset:0
    ds_write_b128 v5, v[68:71] offset:1024
    ds_write_b128 v5, v[72:75] offset:2048
    ds_write_b128 v5, v[76:79] offset:3072
    s_waitcnt vmcnt(0)
    ds_write_b32 v255, v254 offset:240
    s_mov_b32 s66, 0
fw_35:
    ds_read_b128 v[248:251], v253 offset:240
    s_add_u32 s66, s66, 1
    s_cmp_gt_u32 s66, 40000000
    s_cbranch_scc1 L_end
    s_waitcnt lgkmcnt(0)
    v_and_b32 v248, v248, v249
    v_bitop3_b32 v248, v248, v250, v251 bitop3:0x80
    v_cmp_ne_u32 vcc, 1, v248
    s_cbranch_vccnz fw_35
    ds_read_b64_tr_b16 v[96:97], v9 offset:0
    ds_read_b64_tr_b16 v[98:99], v9 offset:1024
    ds_read_b64_tr_b16 v[100:101], v23 offset:0
    ds_read_b64_tr_b16 v[102:103], v23 offset:1024
    ds_read_b64_tr_b16 v[104:105], v9 offset:8192
    ds_read_b64_tr_b16 v[106:107], v9 offset:9216
    ds_read_b64_tr_b16 v[108:109], v23 offset:8192
    ds_read_b64_tr_b16 v[110:111], v23 offset:9216
    ds_read_b64_tr_b16 v[112:113], v9 offset:16384
    ds_read_b64_tr_b16 v[114:115], v9 offset:17408
    ds_read_b64_tr_b16 v[116:117], v23 offset:16384
    ds_read_b64_tr_b16 v[118:119], v23 offset:17408
    ds_read_b64_tr_b16 v[120:121], v9 offset:24576
    ds_read_b64_tr_b16 v[122:123], v9 offset:25600
    s_waitcnt lgkmcnt(9)
    ds_read_b64_tr_b16 v[124:125], v23 offset:24576
    ds_read_b64_tr_b16 v[126:127], v23 offset:25600
    ds_read_b64_tr_b16 v[128:129], v22 offset:0
    ds_read_b64_tr_b16 v[130:131], v22 offset:1024
    ds_read_b64_tr_b16 v[132:133], v17 offset:0
    s_waitcnt lgkmcnt(9)
    ds_read_b64_tr_b16 v[134:135], v17 offset:1024
    ds_read_b64_tr_b16 v[136:137], v22 offset:8192
    ds_read_b64_tr_b16 v[138:139], v22 offset:9216
    ds_read_b64_tr_b16 v[140:141], v17 offset:8192
    ds_read_b64_tr_b16 v[142:143], v17 offset:9216
    s_waitcnt lgkmcnt(9)
    ds_read_b64_tr_b16 v[144:145], v22 offset:16384
    ds_read_b64_tr_b16 v[146:147], v22 offset:17408
    ds_read_b64_tr_b16 v[148:149], v17 offset:16384
    ds_read_b64_tr_b16 v[150:151], v17 offset:17408
    ds_read_b64_tr_b16 v[152:153], v22 offset:24576
    s_waitcnt lgkmcnt(9)
    ds_read_b64_tr_b16 v[154:155], v22 offset:25600
    ds_read_b64_tr_b16 v[156:157], v17 offset:24576
    ds_read_b64_tr_b16 v[158:159], v17 offset:25600
    s_waitcnt lgkmcnt(0)
    s_setprio 3
    s_add_u32 s78, s74, 2097152
    s_mov_b32 s66, 0
gs_36:
    buffer_load_dwordx4 v[192:195], v10, s[48:51], s78 offen offset:0 nt
    buffer_load_dwordx4 v[196:199], v10, s[48:51], s78 offen offset:1024 nt
    buffer_load_dwordx4 v[200:203], v10, s[48:51], s78 offen offset:2048 nt
    buffer_load_dwordx4 v[204:207], v10, s[48:51], s78 offen offset:3072 nt
gsc_37:
    s_waitcnt vmcnt(3)
    v_xor_b32 v192, v192, v240
    v_xor_b32 v193, v193, v241
    v_xor_b32 v194, v194, v242
    v_xor_b32 v195, v195, v243
    v_or3_b32 v248, v192, v193, v194
    v_or_b32 v248, v248, v195
    s_waitcnt vmcnt(2)
    v_xor_b32 v196, v196, v240
    v_xor_b32 v197, v197, v241
    v_xor_b32 v198, v198, v242
    v_xor_b32 v199, v199, v243
    v_or3_b32 v248, v248, v196, v197
    v_or3_b32 v248, v248, v198, v199
    s_waitcnt vmcnt(1)
    v_xor_b32 v200, v200, v240
    v_xor_b32 v201, v201, v241
    v_xor_b32 v202, v202, v242
    v_xor_b32 v203, v203, v243
    v_or3_b32 v248, v248, v200, v201
    v_or3_b32 v248, v248, v202, v203
    s_waitcnt vmcnt(0)
    v_xor_b32 v204, v204, v240
    v_xor_b32 v205, v205, v241
    v_xor_b32 v206, v206, v242
    v_xor_b32 v207, v207, v243
    v_or3_b32 v248, v248, v204, v205
    v_or3_b32 v248, v248, v206, v207
    v_and_b32 v248, s53, v248
    v_cmp_ne_u32 vcc, 0, v248
    s_cbranch_vccz gsd_39
    s_add_u32 s66, s66, 1
    s_cmp_gt_u32 s66, 2000000
    s_cbranch_scc1 L_end
    s_and_b32 s69, s66, 15
    s_cmp_lg_u32 s69, 0
    s_cbranch_scc1 gs_36
    buffer_load_dwordx4 v[192:195], v10, s[48:51], s74 offen offset:0 sc1
    buffer_load_dwordx4 v[196:199], v10, s[48:51], s74 offen offset:1024 sc1
    buffer_load_dwordx4 v[200:203], v10, s[48:51], s74 offen offset:2048 sc1
    buffer_load_dwordx4 v[204:207], v10, s[48:51], s74 offen offset:3072 sc1
    s_branch gsc_37
gsd_39:
    v_mfma_f32_16x16x32_bf16 v[40:43], v[224:227], v[192:195], 0
    v_mfma_f32_16x16x32_bf16 v[40:43], v[224:227], v[196:199], v[40:43]
    v_mfma_f32_16x16x32_bf16 v[40:43], v[228:231], v[200:203], v[40:43]
    v_mfma_f32_16x16x32_bf16 v[40:43], v[228:231], v[204:207], v[40:43]
    s_nop 7
    v_cvt_pk_bf16_f32 v44, v40, v41
    v_cvt_pk_bf16_f32 v45, v42, v43
    s_waitcnt lgkmcnt(0)
    ds_write_b64 v20, v[44:45]
    ds_read_b128 v[160:163], v21 offset:0
    ds_read_b128 v[164:167], v21 offset:64
    ds_read_b128 v[168:171], v21 offset:128
    ds_read_b128 v[172:175], v21 offset:192
    ds_read_b128 v[176:179], v21 offset:256
    ds_read_b128 v[180:183], v21 offset:320
    ds_read_b128 v[184:187], v21 offset:384
    ds_read_b128 v[188:191], v21 offset:448
    s_waitcnt lgkmcnt(7)
    v_mfma_f32_16x16x32_bf16 v[48:51], v[160:163], v[96:99], 0
    v_mfma_f32_16x16x32_bf16 v[52:55], v[160:163], v[100:103], 0
    s_waitcnt lgkmcnt(6)
    v_mfma_f32_16x16x32_bf16 v[48:51], v[164:167], v[104:107], v[48:51]
    v_mfma_f32_16x16x32_bf16 v[52:55], v[164:167], v[108:111], v[52:55]
    s_waitcnt lgkmcnt(5)
    v_mfma_f32_16x16x32_bf16 v[48:51], v[168:171], v[112:115], v[48:51]
    v_mfma_f32_16x16x32_bf16 v[52:55], v[168:171], v[116:119], v[52:55]
    s_waitcnt lgkmcnt(4)
    v_mfma_f32_16x16x32_bf16 v[48:51], v[172:175], v[120:123], v[48:51]
    v_mfma_f32_16x16x32_bf16 v[52:55], v[172:175], v[124:127], v[52:55]
    s_waitcnt lgkmcnt(3)
    v_mfma_f32_16x16x32_bf16 v[48:51], v[176:179], v[128:131], v[48:51]
    v_mfma_f32_16x16x32_bf16 v[52:55], v[176:179], v[132:135], v[52:55]
    s_waitcnt lgkmcnt(2)
    v_mfma_f32_16x16x32_bf16 v[48:51], v[180:183], v[136:139], v[48:51]
    v_mfma_f32_16x16x32_bf16 v[52:55], v[180:183], v[140:143], v[52:55]
    s_waitcnt lgkmcnt(1)
    v_mfma_f32_16x16x32_bf16 v[48:51], v[184:187], v[144:147], v[48:51]
    v_mfma_f32_16x16x32_bf16 v[52:55], v[184:187], v[148:151], v[52:55]
    s_waitcnt lgkmcnt(0)
    v_mfma_f32_16x16x32_bf16 v[48:51], v[188:191], v[152:155], v[48:51]
    v_mfma_f32_16x16x32_bf16 v[52:55], v[188:191], v[156:159], v[52:55]
    s_nop 6
    v_add_u32 v48, 0x10000, v48
    v_add_u32 v52, 0x10000, v52
    v_perm_b32 v44, v52, v48, s76
    v_bfi_b32 v44, s53, v19, v44
    s_mov_b64 exec, 0xffff
    buffer_store_dword v44, v18, s[48:51], s73 offen offset:0 sc1
    s_mov_b64 exec, -1
    s_branch L_fin
L_mlp:
    v_bfe_u32 v6, v2, 2, 1
    v_lshlrev_b32 v6, 4, v6
    v_lshl_add_u32 v6, v3, 2, v6
    v_and_b32 v7, 3, v2
    v_add_u32 v20, v6, v7
    v_lshlrev_b32 v6, 1, v20
    s_lshl_b32 s70, s65, 6
    buffer_load_ushort v224, v6, s[32:35], s70 offen
    v_lshrrev_b32 v6, 2, v2
    v_lshlrev_b32 v6, 5, v6
    v_lshl_add_u32 v6, v7, 2, v6
    v_and_b32 v21, 1, v3
    v_lshl_add_u32 v22, v21, 1, v6
    v_lshlrev_b32 v6, 1, v22
    s_lshl_b32 s70, s64, 8
    buffer_load_dword v226, v6, s[4:7], s70 offen
    buffer_load_dword v227, v6, s[4:7], s70 offen offset:32
    v_lshl_add_u32 v23, v21, 6, v2
    v_lshlrev_b32 v6, 1, v23
    buffer_load_ushort v60, v6, s[40:43], s70 offen
    buffer_load_ushort v61, v6, s[40:43], s70 offen offset:32
    buffer_load_ushort v62, v6, s[40:43], s70 offen offset:64
    buffer_load_ushort v63, v6, s[40:43], s70 offen offset:96
    s_lshl_b32 s70, s64, 14
    s_add_u32 s70, s70, 65536
    v_bfe_u32 v5, v1, 2, 2
    v_and_b32 v6, 3, v1
    v_lshlrev_b32 v6, 3, v6
    v_add_u32 v6, s70, v6
    v_lshl_add_u32 v7, v3, 3, v5
    v_lshl_add_u32 v8, v7, 6, v6
    v_lshl_add_u32 v7, v3, 2, v5
    v_lshl_add_u32 v10, v7, 8, v6
    v_and_b32 v7, 7, v7
    v_lshlrev_b32 v7, 5, v7
    v_add_u32 v10, v10, v7
    s_lshl_b32 s70, s64, 7
    v_lshlrev_b32 v16, 4, v3
    v_add_u32 v16, s70, v16
    v_lshlrev_b32 v19, 2, v20
    v_add_u32 v18, 18688, v19
    v_add_u32 v17, 19200, v19
    v_lshlrev_b32 v7, 10, v3
    v_lshl_add_u32 v7, v2, 4, v7
    s_lshl_b32 s70, s64, 8
    s_add_u32 s73, s70, 19968
    v_lshlrev_b32 v9, 3, v21
    v_lshl_add_u32 v9, v2, 4, v9
    v_add_u32 v9, s73, v9
    v_lshlrev_b32 v11, 4, v3
    v_add_u32 v11, s73, v11
    s_lshl_b32 s72, s64, 9
    s_add_u32 s72, s72, 20992
    v_lshl_add_u32 v12, v22, 2, s72
    v_lshl_add_u32 v15, v23, 2, s72
    s_lshl_b32 s72, s64, 3
    s_add_u32 s72, s72, 19712
    v_mov_b32 v13, s72
    v_mov_b32 v14, 19712
    s_add_u32 s70, s70, 393216
    s_add_u32 s71, s70, 8192
    v_add_u32 v4, 4096, v7
    s_cmp_eq_u32 s65, 0
    s_cselect_b32 s74, -1, 0
    v_lshlrev_b32 v28, 13, v21
    v_lshl_add_u32 v28, v2, 2, v28
    s_lshl_b32 s73, s64, 14
    s_lshl_b32 s72, s65, 6
    s_add_u32 s73, s73, s72
    s_add_u32 s73, s73, 458752
    s_add_u32 s75, s73, 4096

    v_and_b32 v36, 1, v2
    v_lshlrev_b32 v36, 4, v36
    v_mov_b32 v37, 0x3f80
    v_lshlrev_b32 v36, v36, v37
    v_lshrrev_b32 v37, 1, v2

    v_cmp_eq_u32 vcc, 0, v37
    s_nop 1
    v_cndmask_b32 v24, 0, v36, vcc
    v_cmp_eq_u32 vcc, 1, v37
    s_nop 1
    v_cndmask_b32 v25, 0, v36, vcc
    v_cmp_eq_u32 vcc, 2, v37
    s_nop 1
    v_cndmask_b32 v26, 0, v36, vcc
    v_cmp_eq_u32 vcc, 3, v37
    s_nop 1
    v_cndmask_b32 v27, 0, v36, vcc
    v_lshlrev_b32 v36, 1, v2
    v_lshrrev_b32 v36, v36, s52
    v_bfe_u32 v29, v36, 1, 1
    v_and_b32 v36, 1, v36
    v_lshl_or_b32 v29, v29, 16, v36

    v_and_b32 v36, 3, v1
    v_lshlrev_b32 v36, 3, v36
    v_lshrrev_b32 v37, v36, s52
    v_bfe_u32 v240, v37, 0, 1
    v_bfe_u32 v36, v37, 1, 1
    v_lshl_or_b32 v240, v36, 16, v240
    v_bfe_u32 v241, v37, 2, 1
    v_bfe_u32 v36, v37, 3, 1
    v_lshl_or_b32 v241, v36, 16, v241
    v_bfe_u32 v242, v37, 4, 1
    v_bfe_u32 v36, v37, 5, 1
    v_lshl_or_b32 v242, v36, 16, v242
    v_bfe_u32 v243, v37, 6, 1
    v_bfe_u32 v36, v37, 7, 1
    v_lshl_or_b32 v243, v36, 16, v243
    v_cmp_eq_u32 vcc, 0, v2
    s_nop 1
    v_cndmask_b32 v232, 0, -1, vcc
    v_cmp_eq_u32 vcc, 1, v2
    s_nop 1
    v_cndmask_b32 v233, 0, -1, vcc
    v_cmp_eq_u32 vcc, 2, v2
    s_nop 1
    v_cndmask_b32 v234, 0, -1, vcc
    v_cmp_eq_u32 vcc, 3, v2
    s_nop 1
    v_cndmask_b32 v235, 0, -1, vcc
    v_cmp_eq_u32 vcc, 4, v2
    s_nop 1
    v_cndmask_b32 v236, 0, -1, vcc
    v_cmp_eq_u32 vcc, 5, v2
    s_nop 1
    v_cndmask_b32 v237, 0, -1, vcc
    v_cmp_eq_u32 vcc, 6, v2
    s_nop 1
    v_cndmask_b32 v238, 0, -1, vcc
    v_cmp_eq_u32 vcc, 7, v2
    s_nop 1
    v_cndmask_b32 v239, 0, -1, vcc
    v_mov_b32 v32, 0x3f803f80
    v_mov_b32 v33, 0x3f803f80
    v_mov_b32 v34, 0x3f803f80
    v_mov_b32 v35, 0x3f803f80
    s_mov_b32 s78, s70
    s_mov_b32 s79, s71
    v_mov_b32 v5, v7
    v_xor_b32 v192, 0, v10
    v_xor_b32 v193, 32, v10
    v_xor_b32 v194, 64, v10
    v_xor_b32 v195, 96, v10
    v_xor_b32 v196, 128, v10
    v_xor_b32 v197, 160, v10
    v_xor_b32 v198, 192, v10
    v_xor_b32 v199, 224, v10
    s_mov_b32 s66, 0
fw_40:
    s_sleep 1
    ds_read_b128 v[248:251], v253 offset:32
    s_add_u32 s66, s66, 1
    s_cmp_gt_u32 s66, 40000000
    s_cbranch_scc1 L_end
    s_waitcnt lgkmcnt(0)
    v_and_b32 v248, v248, v249
    v_bitop3_b32 v248, v248, v250, v251 bitop3:0x80
    v_cmp_ne_u32 vcc, 1, v248
    s_cbranch_vccnz fw_40
    s_mov_b32 s66, 0
fw_41:
    s_sleep 1
    ds_read_b128 v[248:251], v253 offset:192
    s_add_u32 s66, s66, 1
    s_cmp_gt_u32 s66, 40000000
    s_cbranch_scc1 L_end
    s_waitcnt lgkmcnt(0)
    v_and_b32 v248, v248, v249
    v_bitop3_b32 v248, v248, v250, v251 bitop3:0x80
    v_cmp_ne_u32 vcc, 1, v248
    s_cbranch_vccnz fw_41
    v_lshlrev_b32 v6, 10, v3
    v_lshlrev_b32 v7, 1, v3
    v_xor_b32 v7, v7, v2
    v_lshl_add_u32 v6, v7, 4, v6
    v_xor_b32 v7, 0x80, v6
    s_lshl_b32 s70, s65, 15
    s_lshl_b32 s71, s64, 8
    s_add_u32 s70, s70, s71

    s_add_u32 s72, s70, 0
    buffer_load_dwordx4 v[64:67], v6, s[36:39], s72 offen nt
    s_add_u32 s72, s70, 4096
    buffer_load_dwordx4 v[68:71], v7, s[36:39], s72 offen nt
    s_add_u32 s72, s70, 8192
    buffer_load_dwordx4 v[72:75], v6, s[36:39], s72 offen nt
    s_add_u32 s72, s70, 12288
    buffer_load_dwordx4 v[76:79], v7, s[36:39], s72 offen nt
    s_add_u32 s72, s70, 16384
    buffer_load_dwordx4 v[80:83], v6, s[36:39], s72 offen nt
    s_add_u32 s72, s70, 20480
    buffer_load_dwordx4 v[84:87], v7, s[36:39], s72 offen nt
    s_add_u32 s72, s70, 24576
    buffer_load_dwordx4 v[88:91], v6, s[36:39], s72 offen nt
    s_add_u32 s72, s70, 28672
    buffer_load_dwordx4 v[92:95], v7, s[36:39], s72 offen nt
    v_lshrrev_b32 v6, 3, v1
    v_bfe_u32 v7, v1, 2, 1
    v_lshl_add_u32 v6, v7, 4, v6
    v_mul_u32_u24 v6, 3584, v6
    v_and_b32 v7, 3, v1
    v_lshl_add_u32 v6, v7, 4, v6
    s_mul_i32 s70, s64, 458752
    s_lshl_b32 s71, s65, 6
    s_add_u32 s70, s70, s71

    s_add_u32 s72, s70, 0
    buffer_load_dwordx4 v[200:203], v6, s[28:31], s72 offen nt
    s_add_u32 s72, s70, 28672
    buffer_load_dwordx4 v[204:207], v6, s[28:31], s72 offen nt
    s_mov_b32 s66, 0
fw_42:
    s_sleep 1
    ds_read_b128 v[248:251], v253 offset:48
    s_add_u32 s66, s66, 1
    s_cmp_gt_u32 s66, 40000000
    s_cbranch_scc1 L_end
    s_waitcnt lgkmcnt(0)
    v_and_b32 v248, v248, v249
    v_bitop3_b32 v248, v248, v250, v251 bitop3:0x80
    v_cmp_ne_u32 vcc, 1, v248
    s_cbranch_vccnz fw_42
    v_lshrrev_b32 v6, 3, v1
    v_bfe_u32 v7, v1, 2, 1
    v_lshl_add_u32 v6, v7, 4, v6
    v_mul_u32_u24 v6, 3584, v6
    v_and_b32 v7, 3, v1
    v_lshl_add_u32 v6, v7, 4, v6
    s_mul_i32 s70, s64, 458752
    s_lshl_b32 s71, s65, 6
    s_add_u32 s70, s70, s71

    s_lshl_b32 s69, s64, 14
    s_add_u32 s69, s69, 65536
    s_add_u32 s72, s70, 114688
    s_add_u32 m0, s69, 2048
    s_nop 0
    buffer_load_dwordx4 v6, s[28:31], s72 offen nt lds
    s_add_u32 s72, s70, 143360
    s_add_u32 m0, s69, 3072
    s_nop 0
    buffer_load_dwordx4 v6, s[28:31], s72 offen nt lds
    s_add_u32 s72, s70, 229376
    s_add_u32 m0, s69, 4096
    s_nop 0
    buffer_load_dwordx4 v6, s[28:31], s72 offen nt lds
    s_add_u32 s72, s70, 258048
    s_add_u32 m0, s69, 5120
    s_nop 0
    buffer_load_dwordx4 v6, s[28:31], s72 offen nt lds
    s_add_u32 s72, s70, 344064
    s_add_u32 m0, s69, 6144
    s_nop 0
    buffer_load_dwordx4 v6, s[28:31], s72 offen nt lds
    s_add_u32 s72, s70, 372736
    s_add_u32 m0, s69, 7168
    s_nop 0
    buffer_load_dwordx4 v6, s[28:31], s72 offen nt lds
    v_lshlrev_b32 v6, 10, v3
    v_lshlrev_b32 v7, 1, v3
    v_xor_b32 v7, v7, v2
    v_lshl_add_u32 v6, v7, 4, v6
    v_xor_b32 v7, 0x80, v6
    s_lshl_b32 s70, s65, 15
    s_lshl_b32 s71, s64, 8
    s_add_u32 s70, s70, s71

    s_lshl_b32 s69, s64, 14
    s_add_u32 s69, s69, 73728
    s_mov_b32 s70, s78
    s_mov_b32 s71, s79
    v_mov_b32 v7, v5
    s_waitcnt vmcnt(0)
    v_lshlrev_b32 v5, 4, v1
    v_add_u32 v5, s69, v5
    ds_write_b128 v5, v[64:67] offset:0
    ds_write_b128 v5, v[68:71] offset:1024
    ds_write_b128 v5, v[72:75] offset:2048
    ds_write_b128 v5, v[76:79] offset:3072
    ds_write_b128 v5, v[80:83] offset:4096
    ds_write_b128 v5, v[84:87] offset:5120
    ds_write_b128 v5, v[88:91] offset:6144
    ds_write_b128 v5, v[92:95] offset:7168
    v_subrev_u32 v5, 0x2000, v5
    ds_write_b128 v5, v[200:203] offset:0
    ds_write_b128 v5, v[204:207] offset:1024
    s_waitcnt lgkmcnt(0)
    ds_read_b64_tr_b16 v[96:97], v8 offset:0
    ds_read_b64_tr_b16 v[98:99], v8 offset:256
    ds_read_b64_tr_b16 v[100:101], v8 offset:2048
    ds_read_b64_tr_b16 v[102:103], v8 offset:2304
    ds_read_b64_tr_b16 v[104:105], v8 offset:4096
    ds_read_b64_tr_b16 v[106:107], v8 offset:4352
    ds_read_b64_tr_b16 v[108:109], v8 offset:6144
    ds_read_b64_tr_b16 v[110:111], v8 offset:6400
    ds_read_b64_tr_b16 v[112:113], v8 offset:32
    ds_read_b64_tr_b16 v[114:115], v8 offset:288
    ds_read_b64_tr_b16 v[116:117], v8 offset:2080
    ds_read_b64_tr_b16 v[118:119], v8 offset:2336
    ds_read_b64_tr_b16 v[120:121], v8 offset:4128
    ds_read_b64_tr_b16 v[122:123], v8 offset:4384
    s_waitcnt lgkmcnt(9)
    ds_read_b64_tr_b16 v[124:125], v8 offset:6176
    ds_read_b64_tr_b16 v[126:127], v8 offset:6432
    s_waitcnt lgkmcnt(0)
    v_mfma_f32_16x16x32_bf16 v[40:43], v[96:99], v[32:35], 0
    v_mfma_f32_16x16x32_bf16 v[40:43], v[100:103], v[32:35], v[40:43]
    v_mfma_f32_16x16x32_bf16 v[40:43], v[104:107], v[32:35], v[40:43]
    v_mfma_f32_16x16x32_bf16 v[40:43], v[108:111], v[32:35], v[40:43]
    v_mfma_f32_16x16x32_bf16 v[44:47], v[112:115], v[32:35], 0
    v_mfma_f32_16x16x32_bf16 v[44:47], v[116:119], v[32:35], v[44:47]
    v_mfma_f32_16x16x32_bf16 v[44:47], v[120:123], v[32:35], v[44:47]
    v_mfma_f32_16x16x32_bf16 v[44:47], v[124:127], v[32:35], v[44:47]
    s_nop 3
    ds_write_b128 v16, v[40:43] offset:18688
    s_nop 2
    ds_write_b128 v16, v[44:47] offset:18752
    ds_write_b32 v255, v254 offset:128
    s_waitcnt vmcnt(0)
    ds_read_b64_tr_b16 v[128:129], v192 offset:8192
    ds_read_b64_tr_b16 v[130:131], v192 offset:12288
    ds_read_b64_tr_b16 v[132:133], v193 offset:8192
    ds_read_b64_tr_b16 v[134:135], v193 offset:12288
    ds_read_b64_tr_b16 v[136:137], v194 offset:8192
    ds_read_b64_tr_b16 v[138:139], v194 offset:12288
    ds_read_b64_tr_b16 v[140:141], v195 offset:8192
    ds_read_b64_tr_b16 v[142:143], v195 offset:12288
    ds_read_b64_tr_b16 v[144:145], v196 offset:8192
    ds_read_b64_tr_b16 v[146:147], v196 offset:12288
    ds_read_b64_tr_b16 v[148:149], v197 offset:8192
    s_waitcnt lgkmcnt(9)
    ds_read_b64_tr_b16 v[150:151], v197 offset:12288
    ds_read_b64_tr_b16 v[152:153], v198 offset:8192
    ds_read_b64_tr_b16 v[154:155], v198 offset:12288
    ds_read_b64_tr_b16 v[156:157], v199 offset:8192
    ds_read_b64_tr_b16 v[158:159], v199 offset:12288
    s_waitcnt lgkmcnt(0)
    v_lshlrev_b32 v224, 16, v224
    v_lshlrev_b32 v60, 16, v60
    v_lshlrev_b32 v61, 16, v61
    v_lshlrev_b32 v62, 16, v62
    v_lshlrev_b32 v63, 16, v63
    v_cmp_gt_u32 vcc, 2, v3
    s_nop 1
    v_cndmask_b32 v226, 0, v226, vcc
    v_cndmask_b32 v227, 0, v227, vcc

    s_mov_b32 s66, 0
fw_43:
    ds_read_b128 v[248:251], v253 offset:128
    ds_read2_b32 v[44:45], v18 offset0:0 offset1:32
    ds_read2_b32 v[46:47], v18 offset0:64 offset1:96
    s_add_u32 s66, s66, 1
    s_cmp_gt_u32 s66, 40000000
    s_cbranch_scc1 L_end
    s_waitcnt lgkmcnt(2)
    v_and_b32 v248, v248, v249
    v_bitop3_b32 v248, v248, v250, v251 bitop3:0x80
    v_cmp_ne_u32 vcc, 1, v248
    s_cbranch_vccnz fw_43
    v_lshlrev_b32 v40, 16, v226
    v_lshlrev_b32 v41, 16, v227
    v_and_b32 v42, 0xffff0000, v226
    v_and_b32 v43, 0xffff0000, v227
    s_waitcnt lgkmcnt(0)
    v_add_f32 v44, v44, v45
    v_add_f32 v46, v46, v47
    v_add_f32 v225, v44, v46

    s_setprio 3
    s_and_b32 s72, s64, 1
    s_lshl_b32 s72, s72, 15
    s_lshl_b32 s69, s58, 12
    s_add_u32 s72, s72, s69
    s_lshr_b32 s69, s64, 1
    s_lshl_b32 s69, s69, 11
    s_add_u32 s72, s72, s69
    s_add_u32 s72, s72, 262144
    v_lshlrev_b32 v5, 4, v1

    s_add_u32 s78, s72, 2097152
    s_mov_b32 s66, 0
gs_44:
    buffer_load_dwordx4 v[160:163], v5, s[48:51], s78 offen offset:0 nt
    buffer_load_dwordx4 v[164:167], v5, s[48:51], s78 offen offset:1024 nt
gsc_45:
    s_waitcnt vmcnt(1)
    v_xor_b32 v160, v160, v240
    v_xor_b32 v161, v161, v241
    v_xor_b32 v162, v162, v242
    v_xor_b32 v163, v163, v243
    v_or3_b32 v248, v160, v161, v162
    v_or_b32 v248, v248, v163
    s_waitcnt vmcnt(0)
    v_xor_b32 v164, v164, v240
    v_xor_b32 v165, v165, v241
    v_xor_b32 v166, v166, v242
    v_xor_b32 v167, v167, v243
    v_or3_b32 v248, v248, v164, v165
    v_or3_b32 v248, v248, v166, v167
    v_and_b32 v248, s53, v248
    v_cmp_ne_u32 vcc, 0, v248
    s_cbranch_vccz gsd_47
    s_add_u32 s66, s66, 1
    s_cmp_gt_u32 s66, 2000000
    s_cbranch_scc1 L_end
    s_and_b32 s69, s66, 15
    s_cmp_lg_u32 s69, 0
    s_cbranch_scc1 gs_44
    buffer_load_dwordx4 v[160:163], v5, s[48:51], s72 offen offset:0 sc1
    buffer_load_dwordx4 v[164:167], v5, s[48:51], s72 offen offset:1024 sc1
    s_branch gsc_45
gsd_47:
    ds_write_b32 v255, v254 offset:272
    s_mov_b32 s66, 0
fw_48:
    ds_read_b128 v[248:251], v253 offset:272
    s_add_u32 s66, s66, 1
    s_cmp_gt_u32 s66, 40000000
    s_cbranch_scc1 L_end
    s_waitcnt lgkmcnt(0)
    v_and_b32 v248, v248, v249
    v_bitop3_b32 v248, v248, v250, v251 bitop3:0x80
    v_cmp_ne_u32 vcc, 1, v248
    s_cbranch_vccnz fw_48
    s_sleep 22
    s_mov_b32 s66, 0
gs_49:
    buffer_load_dwordx4 v[160:163], v7, s[48:51], s70 offen offset:0 sc1
    buffer_load_dwordx4 v[164:167], v4, s[48:51], s70 offen offset:0 sc1
    buffer_load_dwordx4 v[168:171], v7, s[48:51], s71 offen offset:0 sc1
    buffer_load_dwordx4 v[172:175], v4, s[48:51], s71 offen offset:0 sc1
gsc_50:
    s_waitcnt vmcnt(3)
    v_xor_b32 v160, v160, v240
    v_xor_b32 v161, v161, v241
    v_xor_b32 v162, v162, v242
    v_xor_b32 v163, v163, v243
    v_or3_b32 v248, v160, v161, v162
    v_or_b32 v248, v248, v163
    s_waitcnt vmcnt(2)
    v_xor_b32 v164, v164, v240
    v_xor_b32 v165, v165, v241
    v_xor_b32 v166, v166, v242
    v_xor_b32 v167, v167, v243
    v_or3_b32 v248, v248, v164, v165
    v_or3_b32 v248, v248, v166, v167
    s_waitcnt vmcnt(1)
    v_xor_b32 v168, v168, v240
    v_xor_b32 v169, v169, v241
    v_xor_b32 v170, v170, v242
    v_xor_b32 v171, v171, v243
    v_or3_b32 v248, v248, v168, v169
    v_or3_b32 v248, v248, v170, v171
    s_waitcnt vmcnt(0)
    v_xor_b32 v172, v172, v240
    v_xor_b32 v173, v173, v241
    v_xor_b32 v174, v174, v242
    v_xor_b32 v175, v175, v243
    v_or3_b32 v248, v248, v172, v173
    v_or3_b32 v248, v248, v174, v175
    v_and_b32 v248, s53, v248
    v_cmp_ne_u32 vcc, 0, v248
    s_cbranch_vccz gsd_52
    s_add_u32 s66, s66, 1
    s_cmp_gt_u32 s66, 2000000
    s_cbranch_scc1 L_end
    s_sleep 2
    s_branch gs_49
gsd_52:
    v_mfma_f32_16x16x32_bf16 v[40:43], v[24:27], v[160:163], v[40:43]
    v_mfma_f32_16x16x32_bf16 v[40:43], v[24:27], v[164:167], v[40:43]
    v_mfma_f32_16x16x32_bf16 v[40:43], v[24:27], v[168:171], v[40:43]
    v_mfma_f32_16x16x32_bf16 v[40:43], v[24:27], v[172:175], v[40:43]
    s_nop 7
    v_cvt_pk_bf16_f32 v44, v40, v41
    v_cvt_pk_bf16_f32 v45, v42, v43
    s_mov_b32 exec_hi, 0
    ds_write_b64 v9, v[44:45]
    ds_write2_b32 v12, v40, v42 offset0:0 offset1:1
    ds_write2_b32 v12, v41, v43 offset0:16 offset1:17
    s_mov_b64 exec, -1
    ds_read_b128 v[176:179], v11
    ds_read_b128 v[180:183], v11 offset:64
    ds_read_b128 v[184:187], v11 offset:128
    ds_read_b128 v[188:191], v11 offset:192
    ds_read2_b32 v[56:57], v15 offset0:0 offset1:16
    ds_read2_b32 v[58:59], v15 offset0:32 offset1:48
    v_add_f32 v36, v40, v41
    v_mul_f32 v37, v40, v40
    v_add_f32 v38, v42, v43
    v_fmac_f32 v37, v41, v41
    v_add_f32 v36, v36, v38
    v_fmac_f32 v37, v42, v42
    v_fmac_f32 v37, v43, v43

    v_add_f32_dpp v36, v36, v36 quad_perm:[1,0,3,2] row_mask:0xf bank_mask:0xf
    s_nop 0
    v_add_f32_dpp v37, v37, v37 quad_perm:[1,0,3,2] row_mask:0xf bank_mask:0xf
    v_add_f32_dpp v36, v36, v36 quad_perm:[2,3,0,1] row_mask:0xf bank_mask:0xf
    s_nop 0
    v_add_f32_dpp v37, v37, v37 quad_perm:[2,3,0,1] row_mask:0xf bank_mask:0xf
    v_add_f32_dpp v36, v36, v36 row_half_mirror row_mask:0xf bank_mask:0xf
    s_nop 0
    v_add_f32_dpp v37, v37, v37 row_half_mirror row_mask:0xf bank_mask:0xf
    v_add_f32_dpp v36, v36, v36 row_mirror row_mask:0xf bank_mask:0xf
    s_nop 0
    v_add_f32_dpp v37, v37, v37 row_mirror row_mask:0xf bank_mask:0xf
    s_waitcnt lgkmcnt(2)
    v_mfma_f32_16x16x32_bf16 v[48:51], v[96:99], v[176:179], 0
    v_mfma_f32_16x16x32_bf16 v[52:55], v[112:115], v[176:179], 0
    v_mfma_f32_16x16x32_bf16 v[48:51], v[100:103], v[180:183], v[48:51]
    v_mfma_f32_16x16x32_bf16 v[52:55], v[116:119], v[180:183], v[52:55]
    v_mfma_f32_16x16x32_bf16 v[48:51], v[104:107], v[184:187], v[48:51]
    v_mfma_f32_16x16x32_bf16 v[52:55], v[120:123], v[184:187], v[52:55]
    v_mfma_f32_16x16x32_bf16 v[48:51], v[108:111], v[188:191], v[48:51]
    v_mfma_f32_16x16x32_bf16 v[52:55], v[124:127], v[188:191], v[52:55]
    v_mov_b32 v38, v36
    v_mov_b32 v39, v37
    s_nop 0
    v_permlane16_swap_b32 v36, v38
    v_permlane16_swap_b32 v37, v39
    v_add_f32 v36, v36, v38
    v_add_f32 v37, v37, v39
    s_mov_b64 exec, 1
    ds_write_b64 v13, v[36:37]
    s_mov_b64 exec, -1
    ds_write_b128 v16, v[48:51] offset:19200
    ds_write_b128 v16, v[52:55] offset:19264
    ds_write_b32 v255, v254 offset:112
    s_cmp_lg_u32 s65, 0
    s_cbranch_scc1 L_nores
    s_waitcnt lgkmcnt(4)
    v_add_f32 v56, v56, v60
    v_add_f32 v57, v57, v61
    v_add_f32 v58, v58, v62
    v_add_f32 v59, v59, v63
    v_add_u32 v60, 0x10000, v56
    v_add_u32 v61, 0x10000, v57
    v_add_u32 v62, 0x10000, v58
    v_add_u32 v63, 0x10000, v59
    v_and_b32 v60, 0xfffe0000, v60
    v_and_b32 v61, 0xfffe0000, v61
    v_and_b32 v62, 0xfffe0000, v62
    v_and_b32 v63, 0xfffe0000, v63
    v_sub_f32 v60, v56, v60
    v_sub_f32 v61, v57, v61
    v_sub_f32 v62, v58, v62
    v_sub_f32 v63, v59, v63
    v_add_u32 v56, 0x10000, v56
    v_add_u32 v57, 0x10000, v57
    v_perm_b32 v200, v57, v56, s76
    v_bfi_b32 v200, s53, v29, v200
    v_add_u32 v58, 0x10000, v58
    v_add_u32 v59, 0x10000, v59
    v_perm_b32 v201, v59, v58, s76
    v_bfi_b32 v201, s53, v29, v201
    v_add_u32 v60, 0x10000, v60
    v_add_u32 v61, 0x10000, v61
    v_perm_b32 v202, v61, v60, s76
    v_bfi_b32 v202, s53, v29, v202
    v_add_u32 v62, 0x10000, v62
    v_add_u32 v63, 0x10000, v63
    v_perm_b32 v203, v63, v62, s76
    v_bfi_b32 v203, s53, v29, v203
    s_mov_b32 exec_hi, 0
    buffer_store_dword v200, v28, s[48:51], s73 offen offset:3584 sc1
    buffer_store_dword v201, v28, s[48:51], s75 offen offset:3584 sc1
    buffer_store_dword v202, v28, s[48:51], s73 offen offset:3648 sc1
    buffer_store_dword v203, v28, s[48:51], s75 offen offset:3648 sc1

    s_mov_b64 exec, -1
L_nores:
    s_mov_b32 s66, 0
fw_53:
    ds_read_b128 v[248:251], v253 offset:112
    ds_read_b128 v[44:47], v14
    ds_read_b128 v[48:51], v14 offset:16
    ds_read2_b32 v[40:41], v17 offset0:0 offset1:32
    ds_read2_b32 v[42:43], v17 offset0:64 offset1:96
    s_add_u32 s66, s66, 1
    s_cmp_gt_u32 s66, 40000000
    s_cbranch_scc1 L_end
    s_waitcnt lgkmcnt(4)
    v_and_b32 v248, v248, v249
    v_bitop3_b32 v248, v248, v250, v251 bitop3:0x80
    v_cmp_ne_u32 vcc, 1, v248
    s_cbranch_vccnz fw_53
    s_waitcnt lgkmcnt(2)
    v_add_f32 v44, v44, v46
    v_add_f32 v48, v48, v50
    v_add_f32 v45, v45, v47
    v_add_f32 v49, v49, v51
    v_add_f32 v36, v44, v48
    v_add_f32 v37, v45, v49
    v_mul_f32 v36, 0x3b000000, v36
    v_mul_f32 v37, 0x3b000000, v37
    v_fma_f32 v37, -v36, v36, v37
    v_max_f32 v37, 0, v37
    v_add_f32 v37, 0x3727c5ac, v37
    v_rsq_f32 v37, v37
    s_waitcnt lgkmcnt(0)
    v_add_f32 v40, v40, v41
    v_add_f32 v42, v42, v43
    v_add_f32 v40, v40, v42
    v_fma_f32 v40, -v36, v225, v40
    v_fma_f32 v40, v40, v37, v224
    v_mul_f32 v41, v40, v40
    v_mov_b32 v42, 0xc0135761
    v_fmac_f32 v42, 0xbdd2d3e8, v41
    v_mul_f32 v41, v40, v42
    v_exp_f32 v41, v41
    s_nop 0
    v_add_f32 v41, 1.0, v41
    v_rcp_f32 v41, v41
    s_nop 0
    v_mul_f32 v40, v40, v41
    s_nop 1
    v_mov_b32_dpp v41, v40 quad_perm:[1,0,3,2] row_mask:0xf bank_mask:0xf
    v_cvt_pk_bf16_f32 v40, v40, v41

    s_nop 1
    v_mov_b32_dpp v44, v40 row_newbcast:0 row_mask:0xf bank_mask:0xf
    v_mov_b32_dpp v45, v40 row_newbcast:2 row_mask:0xf bank_mask:0xf
    v_mov_b32_dpp v46, v40 row_newbcast:4 row_mask:0xf bank_mask:0xf
    v_mov_b32_dpp v47, v40 row_newbcast:6 row_mask:0xf bank_mask:0xf
    v_and_b32 v160, v44, v232
    v_and_b32 v161, v45, v232
    v_and_b32 v162, v46, v232
    v_and_b32 v163, v47, v232
    v_and_b32 v164, v44, v233
    v_and_b32 v165, v45, v233
    v_and_b32 v166, v46, v233
    v_and_b32 v167, v47, v233
    v_mfma_f32_16x16x32_bf16 v[56:59], v[160:163], v[128:131], 0
    v_and_b32 v168, v44, v234
    v_and_b32 v169, v45, v234
    v_and_b32 v170, v46, v234
    v_and_b32 v171, v47, v234
    v_mfma_f32_16x16x32_bf16 v[56:59], v[164:167], v[132:135], v[56:59]
    v_and_b32 v172, v44, v235
    v_and_b32 v173, v45, v235
    v_and_b32 v174, v46, v235
    v_and_b32 v175, v47, v235
    v_mfma_f32_16x16x32_bf16 v[56:59], v[168:171], v[136:139], v[56:59]
    v_and_b32 v176, v44, v236
    v_and_b32 v177, v45, v236
    v_and_b32 v178, v46, v236
    v_and_b32 v179, v47, v236
    v_mfma_f32_16x16x32_bf16 v[56:59], v[172:175], v[140:143], v[56:59]
    v_and_b32 v180, v44, v237
    v_and_b32 v181, v45, v237
    v_and_b32 v182, v46, v237
    v_and_b32 v183, v47, v237
    v_mfma_f32_16x16x32_bf16 v[56:59], v[176:179], v[144:147], v[56:59]
    v_and_b32 v184, v44, v238
    v_and_b32 v185, v45, v238
    v_and_b32 v186, v46, v238
    v_and_b32 v187, v47, v238
    v_mfma_f32_16x16x32_bf16 v[56:59], v[180:183], v[148:151], v[56:59]
    v_and_b32 v188, v44, v239
    v_and_b32 v189, v45, v239
    v_and_b32 v190, v46, v239
    v_and_b32 v191, v47, v239
    v_mfma_f32_16x16x32_bf16 v[56:59], v[184:187], v[152:155], v[56:59]
    s_nop 0
    v_mfma_f32_16x16x32_bf16 v[56:59], v[188:191], v[156:159], v[56:59]
    s_nop 7
    v_add_u32 v56, 0x10000, v56
    v_add_u32 v57, 0x10000, v57
    v_perm_b32 v44, v57, v56, s76
    v_bfi_b32 v44, s53, v29, v44
    v_add_u32 v58, 0x10000, v58
    v_add_u32 v59, 0x10000, v59
    v_perm_b32 v45, v59, v58, s76
    v_bfi_b32 v45, s53, v29, v45
    s_mov_b32 exec_hi, 0
    buffer_store_dword v44, v28, s[48:51], s73 offen sc1
    buffer_store_dword v45, v28, s[48:51], s75 offen sc1
    s_mov_b64 exec, -1
    s_cmp_ge_u32 s54, 2
    s_cbranch_scc1 L_fin
    s_cmp_lg_u32 s64, 0
    s_cbranch_scc1 L_fin
    v_mov_b32 v172, v240
    v_mov_b32 v173, v241
    v_mov_b32 v174, v242
    v_mov_b32 v175, v243
    v_lshlrev_b32 v7, 4, v1
    s_lshl_b32 s73, s58, 1
    s_add_u32 s73, s73, s54
    s_lshl_b32 s70, s73, 12
    s_add_u32 s70, s70, 458752
    v_and_b32 v8, 3, v2
    v_lshlrev_b32 v8, 3, v8
    v_lshl_add_u32 v8, v3, 2, v8
    s_lshl_b32 s71, s73, 6
    v_mov_b32 v9, 0
    v_mov_b32 v10, s57

    s_sleep 12
    s_mov_b32 s66, 0
gs_54:
    buffer_load_dwordx4 v[160:163], v7, s[48:51], s70 offen offset:0 sc1
    buffer_load_dwordx4 v[164:167], v7, s[48:51], s70 offen offset:1024 sc1
    buffer_load_dwordx4 v[168:171], v7, s[48:51], s70 offen offset:2048 sc1
    v_mov_b32 v172, v240
    v_mov_b32 v173, v241
    v_mov_b32 v174, v242
    v_mov_b32 v175, v243
    s_mov_b32 exec_hi, 0xff
    buffer_load_dwordx4 v[172:175], v7, s[48:51], s70 offen offset:3072 sc1
    s_mov_b64 exec, -1
gsc_55:
    s_waitcnt vmcnt(3)
    v_xor_b32 v160, v160, v240
    v_xor_b32 v161, v161, v241
    v_xor_b32 v162, v162, v242
    v_xor_b32 v163, v163, v243
    v_or3_b32 v248, v160, v161, v162
    v_or_b32 v248, v248, v163
    s_waitcnt vmcnt(2)
    v_xor_b32 v164, v164, v240
    v_xor_b32 v165, v165, v241
    v_xor_b32 v166, v166, v242
    v_xor_b32 v167, v167, v243
    v_or3_b32 v248, v248, v164, v165
    v_or3_b32 v248, v248, v166, v167
    s_waitcnt vmcnt(1)
    v_xor_b32 v168, v168, v240
    v_xor_b32 v169, v169, v241
    v_xor_b32 v170, v170, v242
    v_xor_b32 v171, v171, v243
    v_or3_b32 v248, v248, v168, v169
    v_or3_b32 v248, v248, v170, v171
    s_waitcnt vmcnt(0)
    v_xor_b32 v172, v172, v240
    v_xor_b32 v173, v173, v241
    v_xor_b32 v174, v174, v242
    v_xor_b32 v175, v175, v243
    v_or3_b32 v248, v248, v172, v173
    v_or3_b32 v248, v248, v174, v175
    v_and_b32 v248, s53, v248
    v_cmp_ne_u32 vcc, 0, v248
    s_cbranch_vccz gsd_57
    s_add_u32 s66, s66, 1
    s_cmp_gt_u32 s66, 2000000
    s_cbranch_scc1 L_end
    s_sleep 2
    s_branch gs_54
gsd_57:
    v_mfma_f32_16x16x32_bf16 v[40:43], v[24:27], v[160:163], 0
    v_mfma_f32_16x16x32_bf16 v[40:43], v[24:27], v[164:167], v[40:43]
    v_mfma_f32_16x16x32_bf16 v[40:43], v[24:27], v[168:171], v[40:43]
    v_mfma_f32_16x16x32_bf16 v[40:43], v[24:27], v[172:175], v[40:43]
    s_nop 7
    v_add_f32_dpp v40, v40, v40 row_ror:4 row_mask:0xf bank_mask:0xf
    v_add_f32_dpp v41, v41, v41 row_ror:4 row_mask:0xf bank_mask:0xf
    v_add_f32_dpp v42, v42, v42 row_ror:4 row_mask:0xf bank_mask:0xf
    v_add_f32_dpp v43, v43, v43 row_ror:4 row_mask:0xf bank_mask:0xf
    v_add_f32_dpp v40, v40, v40 row_ror:8 row_mask:0xf bank_mask:0xf
    v_add_f32_dpp v41, v41, v41 row_ror:8 row_mask:0xf bank_mask:0xf
    v_add_f32_dpp v42, v42, v42 row_ror:8 row_mask:0xf bank_mask:0xf
    v_add_f32_dpp v43, v43, v43 row_ror:8 row_mask:0xf bank_mask:0xf
    v_cvt_pk_bf16_f32 v48, v40, v42
    v_cvt_pk_bf16_f32 v49, v41, v43
    s_mov_b64 exec, 0x000f000f
    buffer_store_dword v48, v8, s[44:47], s71 offen
    buffer_store_dword v49, v8, s[44:47], s71 offen offset:32
    s_cmp_lg_u32 s73, 0
    s_cbranch_scc1 L_fin2

    s_mov_b64 exec, 1
    buffer_store_dword v10, v9, s[48:51], 0 offen
L_fin2:
    s_mov_b64 exec, -1
L_fin:
L_end:
s_endpgm
.section .rodata,"a"
.p2align 6
.amdhsa_kernel sequential_preLN__compressed_kv_cla__dense_activation_gelu__decode_kernel
  .amdhsa_next_free_vgpr 256
  .amdhsa_next_free_sgpr 102
  .amdhsa_accum_offset 256
  .amdhsa_group_segment_fixed_size 0
  .amdhsa_kernarg_size 112
  .amdhsa_user_sgpr_count 2
  .amdhsa_user_sgpr_kernarg_segment_ptr 1
  .amdhsa_system_sgpr_workgroup_id_x 1
.end_amdhsa_kernel
```
